```python
import torch

def _softmax(x, axis=-1):
    return torch.softmax(x, dim=axis)

def _gelu(x):
    return torch.nn.functional.gelu(x, approximate='tanh')

def _silu(x):
    return torch.nn.functional.silu(x)

def _sigmoid(x):
    return torch.sigmoid(x)

def _layernorm(x, axis=-1, eps=1e-05):
    m = x.mean(dim=axis, keepdim=True)
    v = x.var(dim=axis, keepdim=True, unbiased=False)
    return (x - m) / torch.sqrt(v + eps)

def _scatter_add(tgt, idx, src, axis=0):
    return tgt.clone().index_add_(axis, idx, src)

def _segment_sum(src, seg, n):
    out = torch.zeros((n,) + src.shape[1:], dtype=src.dtype)
    return out.index_add_(0, seg, src)

def _pad(x, pw):
    flat = tuple((v for pair in reversed(pw) for v in pair))
    return torch.nn.functional.pad(x, flat)
kernel_name = 'recurrent_scan__softmax_full_mha__mixer_gmlp__prompt'

def setup_inputs():

    _w = lambda a: (lambda t: t.to(torch.bfloat16) if t.is_floating_point() else t)(torch.as_tensor(a))

    def _A_setup():
        B, S, D = (1, 2048, 640)
        return {'x': _w((lambda *s: torch.randn(*s, dtype=torch.bfloat16) * 0.05)(B, S, D)), 'wqkv': _w((lambda *s: torch.randn(*s, dtype=torch.bfloat16) * 0.05)(D, 3 * D)), 'wo': _w((lambda *s: torch.randn(*s, dtype=torch.bfloat16) * 0.05)(D, D))}
    _A_in = _A_setup()

    def _B_setup():
        B, S, D, F = (1, 2048, 640, 1728)
        Fh = F // 2
        return {'x': _w((lambda *s: torch.randn(*s, dtype=torch.bfloat16) * 0.05)(B, S, D)), 'w_in': _w((lambda *s: torch.randn(*s, dtype=torch.bfloat16) * 1.6)(D, 2 * Fh)), 'w_sp': _w(0.01 * (lambda *s: torch.randn(*s, dtype=torch.bfloat16) * 1.6)(S, S)), 'b_sp': _w(1.0 + 0.01 * (lambda *s: torch.randn(*s, dtype=torch.bfloat16) * 0.05)(S)), 'w_out': _w((lambda *s: torch.randn(*s, dtype=torch.bfloat16) * 0.05)(Fh, D))}
    _B_in = _B_setup()
    return {'A_x': _A_in['x'], 'A_wqkv': _A_in['wqkv'], 'A_wo': _A_in['wo'], 'B_x': _B_in['x'], 'B_w_in': _B_in['w_in'], 'B_w_sp': _B_in['w_sp'], 'B_b_sp': _B_in['b_sp'], 'B_w_out': _B_in['w_out']}

def reference(A_x, A_wqkv, A_wo, B_x, B_w_in, B_w_sp, B_b_sp, B_w_out):

    def _A_ref(x, wqkv, wo):
        B, S, D = x.shape
        H = 32
        Dh = D // H
        qkv = (lambda x, *d: x.permute(*d))((x @ wqkv).reshape(B, S, 3, H, Dh), 2, 0, 3, 1, 4)
        q, k, v = (qkv[0], qkv[1], qkv[2])
        scale = Dh ** (-0.5)
        scores = torch.einsum('bhqd,bhkd->bhqk', q, k) * scale
        p = _softmax(scores, axis=-1)
        o = torch.einsum('bhqk,bhkd->bhqd', p, v)
        return (lambda x, *d: x.permute(*d))(o, 0, 2, 1, 3).reshape(B, S, D) @ wo

    def _B_ref(x, w_in, w_sp, b_sp, w_out):
        B, S, D = x.shape
        F = w_in.shape[-1]
        Fh = F // 2
        z = _gelu(torch.einsum('bsd,df->bsf', x, w_in))
        z1 = z[..., :Fh].clone()
        z2 = _layernorm(z[..., Fh:], axis=-1)
        g = torch.einsum('ts,bsf->btf', w_sp, z2) + b_sp[None, :, None]
        return torch.einsum('bsf,fd->bsd', z1 * g, w_out)
    x = A_x
    xn = _layernorm(x, axis=-1)
    s = _A_ref(xn, A_wqkv, A_wo)
    g = _silu(_B_ref(xn, B_w_in, B_w_sp, B_b_sp, B_w_out))
    return x + s * g
```

```asm
; @launch kernel=k1_kernel grid=(256,1,1) block=(256,1,1) lds=163840
.amdgcn_target "amdgcn-amd-amdhsa--gfx950"
.text
.globl k1_kernel
.p2align 8
.type k1_kernel,@function
k1_kernel:
  s_cmp_ge_u32 s2, 256
  s_cbranch_scc1 k1_end
  s_getpc_b64 s[96:97]
k1_pc:
  v_lshlrev_b32 v253, 6, v0
  v_min_u32 v254, k1_end-k1_pc, v253
  global_load_dword v255, v254, s[96:97]
  v_add_u32 v253, 0x4000, v253
  v_min_u32 v254, k1_end-k1_pc, v253
  global_load_dword v255, v254, s[96:97]
  s_load_dwordx2 s[4:5], s[0:1], 0
  s_load_dwordx2 s[6:7], s[0:1], 8
  s_load_dwordx2 s[8:9], s[0:1], 32
  s_load_dwordx2 s[10:11], s[0:1], 72
  s_load_dwordx2 s[12:13], s[0:1], 80
  s_load_dwordx2 s[14:15], s[0:1], 16
  s_load_dwordx2 s[16:17], s[0:1], 56
  s_load_dwordx2 s[18:19], s[0:1], 40
  s_load_dwordx2 s[20:21], s[0:1], 48
  v_lshrrev_b32 v216, 6, v0
  v_and_b32 v198, 63, v0
  v_readfirstlane_b32 s44, v216
  s_and_b32 s49, s2, 1
  s_bfe_u32 s50, s2, 0x30003
  s_lshl_b32 s49, s49, 3
  s_add_u32 s45, s49, s50
  s_bfe_u32 s49, s2, 0x20001
  s_lshr_b32 s50, s2, 6
  s_lshl_b32 s49, s49, 2
  s_add_u32 s46, s49, s50
  v_lshlrev_b32 v199, 4, v198
  s_cmp_eq_u32 s46, 15
  s_cbranch_scc1 k1_side
  s_and_b32 s47, s44, 1
  s_mov_b32 s59, 0
  s_lshr_b32 s48, s44, 1
  s_lshl_b32 s57, s45, 2
  s_add_u32 s57, s57, s44
  s_mul_i32 s49, s57, 40960
  s_lshl_b32 s55, s44, 14
  s_add_u32 s55, s55, 98304
  s_lshl_b32 s56, s44, 12
  v_lshrrev_b32 v216, 3, v198
  v_lshrrev_b32 v217, 4, v198
  v_and_b32 v218, 7, v198
  v_mul_u32_u24 v216, 1280, v216
  v_xor_b32 v218, v218, v217
  v_lshl_add_u32 v150, v218, 4, v216
  v_xor_b32 v151, 64, v150
  v_add_u32 v151, 9216, v151
  v_add_u32 v152, 18432, v150
  v_add_u32 v153, 18432, v151
  s_cmp_lt_u32 s46, 14
  s_cselect_b32 s50, 2211840, 0
  s_movk_i32 s52, 3456
  s_waitcnt lgkmcnt(0)
  s_add_u32 s24, s4, s49
  s_addc_u32 s25, s5, 0
  s_mov_b32 s26, 40960
  s_mov_b32 s27, 0x20000
  s_mov_b32 s28, s8
  s_mov_b32 s29, s9
  s_mov_b32 s30, s50
  s_mov_b32 s31, 0x20000
  s_mov_b32 s32, s6
  s_mov_b32 s33, s7
  s_mov_b32 s34, 2457600
  s_mov_b32 s35, 0x20000
  v_bfe_u32 v218, v198, 2, 2
  v_xor_b32 v218, v218, v217
  v_and_b32 v219, 3, v198
  v_and_b32 v220, 1, v218
  v_lshlrev_b32 v219, 4, v219
  v_lshl_add_u32 v219, v220, 6, v219
  v_lshrrev_b32 v218, 1, v218
  s_lshl_b32 s49, s44, 4
  v_lshl_add_u32 v217, v218, 6, v217
  v_add_u32 v217, s49, v217
  s_lshl_b32 s49, s46, 7
  v_add_u32 v219, s49, v219
  s_cmp_eq_u32 s46, 0
  s_cselect_b32 s51, 2146435072, 0
  v_xor_b32 v220, 1, v220
  v_mul_lo_u32 v220, v220, s51
  v_mad_u32_u24 v158, v217, s52, v219
  v_add_u32 v154, v158, v220
  v_add_u32 v154, 1664, v154
  s_bfe_u32 s49, s2, 0x30003
  s_lshr_b32 s50, s2, 6
  s_mul_i32 s49, s49, 2
  s_mul_i32 s50, s50, 1
  s_add_u32 s49, s49, s50
  s_mul_i32 s50, s49, 13108
  s_lshr_b32 s50, s50, 16
  s_mul_i32 s50, s50, 5
  s_sub_u32 s60, s49, s50
  v_add_u32 v155, 12800, v154
  v_add_u32 v156, 25600, v154
  v_add_u32 v157, 38400, v154
  s_add_u32 m0, s55, 0
  s_mul_i32 s53, s60, 256
  buffer_load_dwordx4 v150, s[24:27], s53 offen offset:0 lds
  buffer_load_dwordx4 v151, s[24:27], s53 offen offset:1024 lds
  buffer_load_dwordx4 v152, s[24:27], s53 offen offset:2048 lds
  buffer_load_dwordx4 v153, s[24:27], s53 offen offset:3072 lds
  s_add_u32 m0, s56, 0
  s_mul_i32 s54, s60, 442368
  buffer_load_dwordx4 v154, s[28:31], s54 offen offset:0 lds
  buffer_load_dwordx4 v155, s[28:31], s54 offen offset:1024 lds
  buffer_load_dwordx4 v156, s[28:31], s54 offen offset:2048 lds
  buffer_load_dwordx4 v157, s[28:31], s54 offen offset:3072 lds
  s_cmp_ge_u32 s60, 4
  s_cselect_b32 s61, -4, 1
  s_add_u32 s61, s61, s60
  s_cmp_ge_u32 s60, 3
  s_cselect_b32 s62, -3, 2
  s_add_u32 s62, s62, s60
  s_cmp_ge_u32 s60, 2
  s_cselect_b32 s63, -2, 3
  s_add_u32 s63, s63, s60
  s_cmp_ge_u32 s60, 1
  s_cselect_b32 s64, -1, 4
  s_add_u32 s64, s64, s60
  s_movk_i32 s52, 3840
  v_mad_u32_u24 v162, v217, s52, v219
  v_add_u32 v159, 12800, v158
  v_add_u32 v163, 14336, v162
  v_add_u32 v160, 25600, v158
  v_add_u32 v164, 28672, v162
  v_add_u32 v161, 38400, v158
  v_add_u32 v165, 43008, v162
  s_sub_u32 s49, s45, 9
  s_cselect_b32 s49, s45, s49
  s_cselect_b32 s40, s16, s14
  s_cselect_b32 s41, s17, s15
  s_mul_i32 s49, s49, 122880
  s_add_u32 s40, s40, s49
  s_addc_u32 s41, s41, 0
  s_mov_b32 s49, 81920
  s_cmp_eq_u32 s45, 15
  s_cselect_b32 s49, s49, 122880
  s_cmp_eq_u32 s46, 14
  s_cselect_b32 s42, s49, 0
  s_mov_b32 s43, 0x20000
  v_lshlrev_b32 v254, 7, v0
  v_add_u32 v254, 90112, v254
  buffer_load_dword v255, v254, s[40:43], 0 offen
  s_mov_b32 s36, s12
  s_mov_b32 s37, s13
  s_mov_b32 s38, 27262976
  s_mov_b32 s39, 0x20000
  s_mov_b32 s40, s10
  s_mov_b32 s41, s11
  s_mov_b32 s42, 256
  s_mov_b32 s43, 0x20000
  s_lshl_b32 s49, s57, 12
  s_add_u32 s49, s49, 8126464
  s_lshl_b32 s58, s46, 8
  v_lshl_add_u32 v206, v198, 2, s49
  v_lshlrev_b32 v210, 2, v198
  s_add_u32 m0, s55, 4096
  s_add_u32 s53, s53, 128
  buffer_load_dwordx4 v150, s[24:27], s53 offen offset:0 lds
  buffer_load_dwordx4 v151, s[24:27], s53 offen offset:1024 lds
  buffer_load_dwordx4 v152, s[24:27], s53 offen offset:2048 lds
  buffer_load_dwordx4 v153, s[24:27], s53 offen offset:3072 lds
  v_and_b32 v216, 31, v198
  v_lshrrev_b32 v217, 5, v198
  v_bfe_u32 v218, v198, 1, 3
  v_xor_b32 v218, v218, v217
  v_lshlrev_b32 v218, 4, v218
  v_lshl_add_u32 v218, v216, 7, v218
  s_lshl_b32 s49, s48, 5
  v_xor_b32 v218, s49, v218
  v_xor_b32 v219, 0, v218
  v_add_u32 v146, s55, v219
  v_xor_b32 v219, 32, v218
  v_add_u32 v147, s55, v219
  v_xor_b32 v219, 64, v218
  v_add_u32 v148, s55, v219
  v_xor_b32 v219, 96, v218
  v_add_u32 v149, s55, v219
  v_lshlrev_b32 v219, 6, v216
  v_lshl_add_u32 v219, v217, 4, v219
  s_add_u32 s49, s55, 4096
  v_bfe_u32 v220, v198, 1, 2
  v_lshlrev_b32 v220, 4, v220
  v_xor_b32 v219, v219, v220
  v_add_u32 v208, s49, v219
  v_xor_b32 v212, 32, v208
  v_lshlrev_b32 v219, 3, v216
  v_add_u32 v207, s55, v219
  v_lshl_add_u32 v225, v217, 15, v219
  v_bfe_u32 v218, v198, 2, 2
  v_lshl_add_u32 v219, v217, 3, v218
  v_and_b32 v220, 1, v198
  v_bfe_u32 v221, v198, 1, 1
  v_bfe_u32 v222, v198, 4, 1
  v_lshlrev_b32 v220, 4, v220
  v_lshl_add_u32 v220, v221, 3, v220
  v_lshl_add_u32 v220, v222, 5, v220
  v_lshl_add_u32 v221, v219, 6, v220
  v_and_b32 v223, 8, v198
  v_lshlrev_b32 v223, 1, v223
  v_xor_b32 v221, v221, v223
  v_add_u32 v209, s49, v221
  v_xor_b32 v213, 32, v209
  v_lshl_add_u32 v220, v219, 8, v220
  v_xor_b32 v218, s47, v218
  v_lshl_add_u32 v220, v218, 6, v220
  s_lshl_b32 s49, s48, 12
  v_xor_b32 v220, s49, v220
  v_xor_b32 v130, 0, v220
  v_add_u32 v138, 49152, v130
  v_xor_b32 v131, 64, v220
  v_add_u32 v139, 49152, v131
  v_xor_b32 v132, 128, v220
  v_add_u32 v140, 49152, v132
  v_xor_b32 v133, 192, v220
  v_add_u32 v141, 49152, v133
  v_xor_b32 v134, 4096, v220
  v_add_u32 v142, 49152, v134
  v_xor_b32 v135, 4160, v220
  v_add_u32 v143, 49152, v135
  v_xor_b32 v136, 4224, v220
  v_add_u32 v144, 49152, v136
  v_xor_b32 v137, 4288, v220
  v_add_u32 v145, 49152, v137
  s_add_u32 m0, s55, 8192
  s_mul_i32 s53, s61, 256
  buffer_load_dwordx4 v150, s[24:27], s53 offen offset:0 lds
  buffer_load_dwordx4 v151, s[24:27], s53 offen offset:1024 lds
  buffer_load_dwordx4 v152, s[24:27], s53 offen offset:2048 lds
  buffer_load_dwordx4 v153, s[24:27], s53 offen offset:3072 lds
  v_and_b32 v254, 1, v198
  v_bfe_u32 v253, v198, 1, 1
  v_mul_u32_u24 v254, 0x700000, v254
  v_mul_u32_u24 v253, 0x3f0000, v253
  v_add_u32 v253, v253, v254
  v_cmp_eq_u32 vcc, 0, v254
  v_add_u32 v253, 0x500000, v253
  v_mov_b32 v254, 0x500000
  v_cndmask_b32 v253, v253, v254, vcc
  s_lshl_b32 s49, s47, 14
  s_add_u32 s50, s49, 98304
  s_xor_b32 s49, s49, 16384
  s_add_u32 s49, s49, 98304
  v_add_u32 v196, s50, v225
  v_add_u32 v197, s49, v225
  v_bfe_u32 v216, v198, 2, 1
  v_and_b32 v217, 3, v198
  v_xor_b32 v216, v216, v222
  v_or_b32 v216, v216, v217
  v_cmp_eq_u32 vcc, 0, v216
  v_mov_b32 v217, 0x3f803f80
  v_mov_b32 v204, 0
  v_mov_b32 v205, 0
  v_cndmask_b32 v166, 0, v217, vcc
  v_cndmask_b32 v167, 0, v217, vcc
  v_cndmask_b32 v168, 0, v217, vcc
  v_cndmask_b32 v169, 0, v217, vcc
  s_waitcnt vmcnt(9)
  s_barrier
  ds_read_b128 a[0:3], v146 offset:0
  ds_read_b64_tr_b16 a[160:161], v130 offset:0
  ds_read_b64_tr_b16 a[162:163], v130 offset:1024
  ds_read_b64_tr_b16 a[164:165], v131 offset:0
  ds_read_b64_tr_b16 a[166:167], v131 offset:1024
  ds_read_b128 a[4:7], v147 offset:0
  ds_read_b64_tr_b16 a[168:169], v134 offset:0
  ds_read_b64_tr_b16 a[170:171], v134 offset:1024
  ds_read_b64_tr_b16 a[172:173], v135 offset:0
  ds_read_b64_tr_b16 a[174:175], v135 offset:1024
  ds_read_b128 a[8:11], v148 offset:0
  ds_read_b128 a[12:15], v149 offset:0
  ds_read_b64_tr_b16 a[176:177], v130 offset:8192
  ds_read_b64_tr_b16 a[178:179], v130 offset:9216
  ds_read_b64_tr_b16 a[180:181], v131 offset:8192
  ds_read_b64_tr_b16 a[182:183], v131 offset:9216
  s_waitcnt lgkmcnt(11)
  v_mfma_f32_32x32x16_bf16 v[2:17], a[160:163], a[0:3], 0
  ds_read_b64_tr_b16 a[184:185], v134 offset:8192
  ds_read_b64_tr_b16 a[186:187], v134 offset:9216
  v_mfma_f32_16x16x32_bf16 v[170:173], v[166:169], a[160:163], 0
  v_mfma_f32_16x16x32_bf16 v[178:181], v[166:169], a[0:3], 0
  v_mfma_f32_32x32x16_bf16 v[18:33], a[164:167], a[0:3], 0
  s_waitcnt lgkmcnt(8)
  ds_read_b64_tr_b16 a[188:189], v135 offset:8192
  ds_read_b64_tr_b16 a[190:191], v135 offset:9216
  s_add_u32 m0, s56, 16384
  s_mul_i32 s54, s61, 442368
  buffer_load_dwordx4 v154, s[28:31], s54 offen offset:0 lds
  v_mfma_f32_4x4x4_16b_bf16 v[182:185], a[0:1], a[0:1], 0
  v_mfma_f32_4x4x4_16b_bf16 v[186:189], a[2:3], a[2:3], 0
  v_mfma_f32_32x32x16_bf16 v[2:17], a[168:171], a[4:7], v[2:17]
  s_waitcnt vmcnt(5)
  ds_read_b128 a[16:19], v146 offset:4096
  ds_read_b128 a[20:23], v147 offset:4096
  ds_read_b64_tr_b16 a[160:161], v132 offset:0
  ds_read_b64_tr_b16 a[162:163], v132 offset:1024
  buffer_load_dwordx4 v155, s[28:31], s54 offen offset:1024 lds
  v_mfma_f32_16x16x32_bf16 v[178:181], v[166:169], a[4:7], v[178:181]
  v_mfma_f32_32x32x16_bf16 v[18:33], a[172:175], a[4:7], v[18:33]
  s_waitcnt lgkmcnt(8)
  ds_read_b128 a[24:27], v148 offset:4096
  ds_read_b128 a[28:31], v149 offset:4096
  ds_read_b64_tr_b16 a[164:165], v133 offset:0
  ds_read_b64_tr_b16 a[166:167], v133 offset:1024
  buffer_load_dwordx4 v156, s[28:31], s54 offen offset:2048 lds
  v_mfma_f32_4x4x4_16b_bf16 v[182:185], a[4:5], a[4:5], v[182:185]
  v_mfma_f32_4x4x4_16b_bf16 v[186:189], a[6:7], a[6:7], v[186:189]
  v_mfma_f32_32x32x16_bf16 v[2:17], a[176:179], a[8:11], v[2:17]
  ds_read_b64_tr_b16 a[168:169], v136 offset:0
  ds_read_b64_tr_b16 a[170:171], v136 offset:1024
  buffer_load_dwordx4 v157, s[28:31], s54 offen offset:3072 lds
  v_mfma_f32_16x16x32_bf16 v[170:173], v[166:169], a[176:179], v[170:173]
  v_mfma_f32_16x16x32_bf16 v[178:181], v[166:169], a[8:11], v[178:181]
  v_mfma_f32_32x32x16_bf16 v[18:33], a[180:183], a[8:11], v[18:33]
  s_waitcnt lgkmcnt(10)
  ds_read_b64_tr_b16 a[172:173], v137 offset:0
  ds_read_b64_tr_b16 a[174:175], v137 offset:1024
  v_mfma_f32_4x4x4_16b_bf16 v[182:185], a[8:9], a[8:9], v[182:185]
  v_mfma_f32_4x4x4_16b_bf16 v[186:189], a[10:11], a[10:11], v[186:189]
  v_mfma_f32_32x32x16_bf16 v[2:17], a[184:187], a[12:15], v[2:17]
  ds_read_b64_tr_b16 a[176:177], v132 offset:8192
  ds_read_b64_tr_b16 a[178:179], v132 offset:9216
  s_add_u32 m0, s55, 12288
  s_add_u32 s53, s53, 128
  buffer_load_dwordx4 v150, s[24:27], s53 offen offset:0 lds
  v_mfma_f32_16x16x32_bf16 v[178:181], v[166:169], a[12:15], v[178:181]
  v_mfma_f32_32x32x16_bf16 v[18:33], a[188:191], a[12:15], v[18:33]
  s_waitcnt lgkmcnt(6)
  ds_read_b64_tr_b16 a[180:181], v133 offset:8192
  ds_read_b64_tr_b16 a[182:183], v133 offset:9216
  buffer_load_dwordx4 v151, s[24:27], s53 offen offset:1024 lds
  v_mfma_f32_4x4x4_16b_bf16 v[182:185], a[12:13], a[12:13], v[182:185]
  v_mfma_f32_4x4x4_16b_bf16 v[186:189], a[14:15], a[14:15], v[186:189]
  v_mfma_f32_32x32x16_bf16 v[2:17], a[160:163], a[16:19], v[2:17]
  ds_read_b64_tr_b16 a[184:185], v136 offset:8192
  ds_read_b64_tr_b16 a[186:187], v136 offset:9216
  buffer_load_dwordx4 v152, s[24:27], s53 offen offset:2048 lds
  v_mfma_f32_16x16x32_bf16 v[170:173], v[166:169], a[160:163], v[170:173]
  v_mfma_f32_16x16x32_bf16 v[178:181], v[166:169], a[16:19], v[178:181]
  v_mfma_f32_32x32x16_bf16 v[18:33], a[164:167], a[16:19], v[18:33]
  s_waitcnt lgkmcnt(6)
  ds_read_b64_tr_b16 a[188:189], v137 offset:8192
  ds_read_b64_tr_b16 a[190:191], v137 offset:9216
  buffer_load_dwordx4 v153, s[24:27], s53 offen offset:3072 lds
  v_mfma_f32_4x4x4_16b_bf16 v[182:185], a[16:17], a[16:17], v[182:185]
  v_mfma_f32_4x4x4_16b_bf16 v[186:189], a[18:19], a[18:19], v[186:189]
  v_mfma_f32_32x32x16_bf16 v[2:17], a[168:171], a[20:23], v[2:17]
  s_waitcnt vmcnt(4)
  s_barrier
  ds_read_b128 a[32:35], v146 offset:8192
  ds_read_b128 a[36:39], v147 offset:8192
  ds_read_b64_tr_b16 a[160:161], v130 offset:16384
  ds_read_b64_tr_b16 a[162:163], v130 offset:17408
  v_mfma_f32_16x16x32_bf16 v[178:181], v[166:169], a[20:23], v[178:181]
  v_mfma_f32_32x32x16_bf16 v[18:33], a[172:175], a[20:23], v[18:33]
  s_waitcnt lgkmcnt(8)
  ds_read_b128 a[40:43], v148 offset:8192
  ds_read_b128 a[44:47], v149 offset:8192
  ds_read_b64_tr_b16 a[164:165], v131 offset:16384
  ds_read_b64_tr_b16 a[166:167], v131 offset:17408
  s_add_u32 m0, s55, 0
  s_mul_i32 s53, s62, 256
  buffer_load_dwordx4 v150, s[24:27], s53 offen offset:0 lds
  v_mfma_f32_4x4x4_16b_bf16 v[182:185], a[20:21], a[20:21], v[182:185]
  v_mfma_f32_4x4x4_16b_bf16 v[186:189], a[22:23], a[22:23], v[186:189]
  v_mfma_f32_32x32x16_bf16 v[2:17], a[176:179], a[24:27], v[2:17]
  ds_read_b64_tr_b16 a[168:169], v134 offset:16384
  ds_read_b64_tr_b16 a[170:171], v134 offset:17408
  buffer_load_dwordx4 v151, s[24:27], s53 offen offset:1024 lds
  v_mfma_f32_16x16x32_bf16 v[170:173], v[166:169], a[176:179], v[170:173]
  v_mfma_f32_16x16x32_bf16 v[178:181], v[166:169], a[24:27], v[178:181]
  v_mfma_f32_32x32x16_bf16 v[18:33], a[180:183], a[24:27], v[18:33]
  s_waitcnt lgkmcnt(10)
  ds_read_b64_tr_b16 a[172:173], v135 offset:16384
  ds_read_b64_tr_b16 a[174:175], v135 offset:17408
  buffer_load_dwordx4 v152, s[24:27], s53 offen offset:2048 lds
  v_mfma_f32_4x4x4_16b_bf16 v[182:185], a[24:25], a[24:25], v[182:185]
  v_mfma_f32_4x4x4_16b_bf16 v[186:189], a[26:27], a[26:27], v[186:189]
  v_mfma_f32_32x32x16_bf16 v[2:17], a[184:187], a[28:31], v[2:17]
  ds_read_b64_tr_b16 a[176:177], v130 offset:24576
  ds_read_b64_tr_b16 a[178:179], v130 offset:25600
  buffer_load_dwordx4 v153, s[24:27], s53 offen offset:3072 lds
  v_mfma_f32_16x16x32_bf16 v[178:181], v[166:169], a[28:31], v[178:181]
  v_mfma_f32_32x32x16_bf16 v[18:33], a[188:191], a[28:31], v[18:33]
  s_waitcnt lgkmcnt(6)
  ds_read_b64_tr_b16 a[180:181], v131 offset:24576
  ds_read_b64_tr_b16 a[182:183], v131 offset:25600
  v_mfma_f32_4x4x4_16b_bf16 v[182:185], a[28:29], a[28:29], v[182:185]
  v_mfma_f32_4x4x4_16b_bf16 v[186:189], a[30:31], a[30:31], v[186:189]
  v_mfma_f32_32x32x16_bf16 v[2:17], a[160:163], a[32:35], v[2:17]
  ds_read_b64_tr_b16 a[184:185], v134 offset:24576
  ds_read_b64_tr_b16 a[186:187], v134 offset:25600
  s_add_u32 m0, s56, 32768
  s_mul_i32 s54, s62, 442368
  buffer_load_dwordx4 v154, s[28:31], s54 offen offset:0 lds
  v_mfma_f32_16x16x32_bf16 v[170:173], v[166:169], a[160:163], v[170:173]
  v_mfma_f32_16x16x32_bf16 v[178:181], v[166:169], a[32:35], v[178:181]
  v_mfma_f32_32x32x16_bf16 v[18:33], a[164:167], a[32:35], v[18:33]
  s_waitcnt lgkmcnt(6)
  ds_read_b64_tr_b16 a[188:189], v135 offset:24576
  ds_read_b64_tr_b16 a[190:191], v135 offset:25600
  buffer_load_dwordx4 v155, s[28:31], s54 offen offset:1024 lds
  v_mfma_f32_4x4x4_16b_bf16 v[182:185], a[32:33], a[32:33], v[182:185]
  v_mfma_f32_4x4x4_16b_bf16 v[186:189], a[34:35], a[34:35], v[186:189]
  v_mfma_f32_32x32x16_bf16 v[2:17], a[168:171], a[36:39], v[2:17]
  s_waitcnt vmcnt(6)
  ds_read_b128 a[48:51], v146 offset:12288
  ds_read_b128 a[52:55], v147 offset:12288
  ds_read_b64_tr_b16 a[160:161], v132 offset:16384
  ds_read_b64_tr_b16 a[162:163], v132 offset:17408
  buffer_load_dwordx4 v156, s[28:31], s54 offen offset:2048 lds
  v_mfma_f32_16x16x32_bf16 v[178:181], v[166:169], a[36:39], v[178:181]
  v_mfma_f32_32x32x16_bf16 v[18:33], a[172:175], a[36:39], v[18:33]
  s_waitcnt lgkmcnt(8)
  ds_read_b128 a[56:59], v148 offset:12288
  ds_read_b128 a[60:63], v149 offset:12288
  ds_read_b64_tr_b16 a[164:165], v133 offset:16384
  ds_read_b64_tr_b16 a[166:167], v133 offset:17408
  buffer_load_dwordx4 v157, s[28:31], s54 offen offset:3072 lds
  v_mfma_f32_4x4x4_16b_bf16 v[182:185], a[36:37], a[36:37], v[182:185]
  v_mfma_f32_4x4x4_16b_bf16 v[186:189], a[38:39], a[38:39], v[186:189]
  v_mfma_f32_32x32x16_bf16 v[2:17], a[176:179], a[40:43], v[2:17]
  ds_read_b64_tr_b16 a[168:169], v136 offset:16384
  ds_read_b64_tr_b16 a[170:171], v136 offset:17408
  v_mfma_f32_16x16x32_bf16 v[170:173], v[166:169], a[176:179], v[170:173]
  v_mfma_f32_16x16x32_bf16 v[178:181], v[166:169], a[40:43], v[178:181]
  v_mfma_f32_32x32x16_bf16 v[18:33], a[180:183], a[40:43], v[18:33]
  s_waitcnt lgkmcnt(10)
  ds_read_b64_tr_b16 a[172:173], v137 offset:16384
  ds_read_b64_tr_b16 a[174:175], v137 offset:17408
  s_add_u32 m0, s55, 4096
  s_add_u32 s53, s53, 128
  buffer_load_dwordx4 v150, s[24:27], s53 offen offset:0 lds
  v_mfma_f32_4x4x4_16b_bf16 v[182:185], a[40:41], a[40:41], v[182:185]
  v_mfma_f32_4x4x4_16b_bf16 v[186:189], a[42:43], a[42:43], v[186:189]
  v_mfma_f32_32x32x16_bf16 v[2:17], a[184:187], a[44:47], v[2:17]
  ds_read_b64_tr_b16 a[176:177], v132 offset:24576
  ds_read_b64_tr_b16 a[178:179], v132 offset:25600
  buffer_load_dwordx4 v151, s[24:27], s53 offen offset:1024 lds
  v_mfma_f32_16x16x32_bf16 v[178:181], v[166:169], a[44:47], v[178:181]
  v_mfma_f32_32x32x16_bf16 v[18:33], a[188:191], a[44:47], v[18:33]
  s_waitcnt lgkmcnt(6)
  ds_read_b64_tr_b16 a[180:181], v133 offset:24576
  ds_read_b64_tr_b16 a[182:183], v133 offset:25600
  buffer_load_dwordx4 v152, s[24:27], s53 offen offset:2048 lds
  v_mfma_f32_4x4x4_16b_bf16 v[182:185], a[44:45], a[44:45], v[182:185]
  v_mfma_f32_4x4x4_16b_bf16 v[186:189], a[46:47], a[46:47], v[186:189]
  v_mfma_f32_32x32x16_bf16 v[2:17], a[160:163], a[48:51], v[2:17]
  ds_read_b64_tr_b16 a[184:185], v136 offset:24576
  ds_read_b64_tr_b16 a[186:187], v136 offset:25600
  buffer_load_dwordx4 v153, s[24:27], s53 offen offset:3072 lds
  v_mfma_f32_16x16x32_bf16 v[170:173], v[166:169], a[160:163], v[170:173]
  v_mfma_f32_16x16x32_bf16 v[178:181], v[166:169], a[48:51], v[178:181]
  v_mfma_f32_32x32x16_bf16 v[18:33], a[164:167], a[48:51], v[18:33]
  s_waitcnt lgkmcnt(6)
  ds_read_b64_tr_b16 a[188:189], v137 offset:24576
  ds_read_b64_tr_b16 a[190:191], v137 offset:25600
  v_mfma_f32_4x4x4_16b_bf16 v[182:185], a[48:49], a[48:49], v[182:185]
  v_mfma_f32_4x4x4_16b_bf16 v[186:189], a[50:51], a[50:51], v[186:189]
  v_mfma_f32_32x32x16_bf16 v[2:17], a[168:171], a[52:55], v[2:17]
  s_waitcnt vmcnt(4)
  s_barrier
  ds_read_b128 a[64:67], v146 offset:0
  ds_read_b128 a[68:71], v147 offset:0
  ds_read_b64_tr_b16 a[160:161], v130 offset:32768
  ds_read_b64_tr_b16 a[162:163], v130 offset:33792
  s_add_u32 m0, s55, 8192
  s_mul_i32 s53, s63, 256
  buffer_load_dwordx4 v150, s[24:27], s53 offen offset:0 lds
  v_mfma_f32_16x16x32_bf16 v[178:181], v[166:169], a[52:55], v[178:181]
  v_mfma_f32_32x32x16_bf16 v[18:33], a[172:175], a[52:55], v[18:33]
  s_waitcnt lgkmcnt(8)
  ds_read_b128 a[72:75], v148 offset:0
  ds_read_b128 a[76:79], v149 offset:0
  ds_read_b64_tr_b16 a[164:165], v131 offset:32768
  ds_read_b64_tr_b16 a[166:167], v131 offset:33792
  buffer_load_dwordx4 v151, s[24:27], s53 offen offset:1024 lds
  v_mfma_f32_4x4x4_16b_bf16 v[182:185], a[52:53], a[52:53], v[182:185]
  v_mfma_f32_4x4x4_16b_bf16 v[186:189], a[54:55], a[54:55], v[186:189]
  v_mfma_f32_32x32x16_bf16 v[2:17], a[176:179], a[56:59], v[2:17]
  ds_read_b64_tr_b16 a[168:169], v134 offset:32768
  ds_read_b64_tr_b16 a[170:171], v134 offset:33792
  buffer_load_dwordx4 v152, s[24:27], s53 offen offset:2048 lds
  v_mfma_f32_16x16x32_bf16 v[170:173], v[166:169], a[176:179], v[170:173]
  v_mfma_f32_16x16x32_bf16 v[178:181], v[166:169], a[56:59], v[178:181]
  v_mfma_f32_32x32x16_bf16 v[18:33], a[180:183], a[56:59], v[18:33]
  s_waitcnt lgkmcnt(10)
  ds_read_b64_tr_b16 a[172:173], v135 offset:32768
  ds_read_b64_tr_b16 a[174:175], v135 offset:33792
  buffer_load_dwordx4 v153, s[24:27], s53 offen offset:3072 lds
  v_mfma_f32_4x4x4_16b_bf16 v[182:185], a[56:57], a[56:57], v[182:185]
  v_mfma_f32_4x4x4_16b_bf16 v[186:189], a[58:59], a[58:59], v[186:189]
  v_mfma_f32_32x32x16_bf16 v[2:17], a[184:187], a[60:63], v[2:17]
  ds_read_b64_tr_b16 a[176:177], v130 offset:40960
  ds_read_b64_tr_b16 a[178:179], v130 offset:41984
  v_mfma_f32_16x16x32_bf16 v[178:181], v[166:169], a[60:63], v[178:181]
  v_mfma_f32_32x32x16_bf16 v[18:33], a[188:191], a[60:63], v[18:33]
  s_waitcnt lgkmcnt(6)
  ds_read_b64_tr_b16 a[180:181], v131 offset:40960
  ds_read_b64_tr_b16 a[182:183], v131 offset:41984
  s_add_u32 m0, s56, 49152
  s_mul_i32 s54, s63, 442368
  buffer_load_dwordx4 v154, s[28:31], s54 offen offset:0 lds
  v_mfma_f32_4x4x4_16b_bf16 v[182:185], a[60:61], a[60:61], v[182:185]
  v_mfma_f32_4x4x4_16b_bf16 v[186:189], a[62:63], a[62:63], v[186:189]
  v_mfma_f32_32x32x16_bf16 v[2:17], a[160:163], a[64:67], v[2:17]
  ds_read_b64_tr_b16 a[184:185], v134 offset:40960
  ds_read_b64_tr_b16 a[186:187], v134 offset:41984
  buffer_load_dwordx4 v155, s[28:31], s54 offen offset:1024 lds
  v_mfma_f32_16x16x32_bf16 v[170:173], v[166:169], a[160:163], v[170:173]
  v_mfma_f32_16x16x32_bf16 v[178:181], v[166:169], a[64:67], v[178:181]
  v_mfma_f32_32x32x16_bf16 v[18:33], a[164:167], a[64:67], v[18:33]
  s_waitcnt lgkmcnt(6)
  ds_read_b64_tr_b16 a[188:189], v135 offset:40960
  ds_read_b64_tr_b16 a[190:191], v135 offset:41984
  buffer_load_dwordx4 v156, s[28:31], s54 offen offset:2048 lds
  v_mfma_f32_4x4x4_16b_bf16 v[182:185], a[64:65], a[64:65], v[182:185]
  v_mfma_f32_4x4x4_16b_bf16 v[186:189], a[66:67], a[66:67], v[186:189]
  v_mfma_f32_32x32x16_bf16 v[2:17], a[168:171], a[68:71], v[2:17]
  s_waitcnt vmcnt(7)
  ds_read_b128 a[80:83], v146 offset:4096
  ds_read_b128 a[84:87], v147 offset:4096
  ds_read_b64_tr_b16 a[160:161], v132 offset:32768
  ds_read_b64_tr_b16 a[162:163], v132 offset:33792
  buffer_load_dwordx4 v157, s[28:31], s54 offen offset:3072 lds
  v_mfma_f32_16x16x32_bf16 v[178:181], v[166:169], a[68:71], v[178:181]
  v_mfma_f32_32x32x16_bf16 v[18:33], a[172:175], a[68:71], v[18:33]
  s_waitcnt lgkmcnt(8)
  ds_read_b128 a[88:91], v148 offset:4096
  ds_read_b128 a[92:95], v149 offset:4096
  ds_read_b64_tr_b16 a[164:165], v133 offset:32768
  ds_read_b64_tr_b16 a[166:167], v133 offset:33792
  v_mfma_f32_4x4x4_16b_bf16 v[182:185], a[68:69], a[68:69], v[182:185]
  v_mfma_f32_4x4x4_16b_bf16 v[186:189], a[70:71], a[70:71], v[186:189]
  v_mfma_f32_32x32x16_bf16 v[2:17], a[176:179], a[72:75], v[2:17]
  ds_read_b64_tr_b16 a[168:169], v136 offset:32768
  ds_read_b64_tr_b16 a[170:171], v136 offset:33792
  s_add_u32 m0, s55, 12288
  s_add_u32 s53, s53, 128
  buffer_load_dwordx4 v150, s[24:27], s53 offen offset:0 lds
  v_mfma_f32_16x16x32_bf16 v[170:173], v[166:169], a[176:179], v[170:173]
  v_mfma_f32_16x16x32_bf16 v[178:181], v[166:169], a[72:75], v[178:181]
  v_mfma_f32_32x32x16_bf16 v[18:33], a[180:183], a[72:75], v[18:33]
  s_waitcnt lgkmcnt(10)
  ds_read_b64_tr_b16 a[172:173], v137 offset:32768
  ds_read_b64_tr_b16 a[174:175], v137 offset:33792
  buffer_load_dwordx4 v151, s[24:27], s53 offen offset:1024 lds
  v_mfma_f32_4x4x4_16b_bf16 v[182:185], a[72:73], a[72:73], v[182:185]
  v_mfma_f32_4x4x4_16b_bf16 v[186:189], a[74:75], a[74:75], v[186:189]
  v_mfma_f32_32x32x16_bf16 v[2:17], a[184:187], a[76:79], v[2:17]
  ds_read_b64_tr_b16 a[176:177], v132 offset:40960
  ds_read_b64_tr_b16 a[178:179], v132 offset:41984
  buffer_load_dwordx4 v152, s[24:27], s53 offen offset:2048 lds
  v_mfma_f32_16x16x32_bf16 v[178:181], v[166:169], a[76:79], v[178:181]
  v_mfma_f32_32x32x16_bf16 v[18:33], a[188:191], a[76:79], v[18:33]
  s_waitcnt lgkmcnt(6)
  ds_read_b64_tr_b16 a[180:181], v133 offset:40960
  ds_read_b64_tr_b16 a[182:183], v133 offset:41984
  buffer_load_dwordx4 v153, s[24:27], s53 offen offset:3072 lds
  v_mfma_f32_4x4x4_16b_bf16 v[182:185], a[76:77], a[76:77], v[182:185]
  v_mfma_f32_4x4x4_16b_bf16 v[186:189], a[78:79], a[78:79], v[186:189]
  v_mfma_f32_32x32x16_bf16 v[2:17], a[160:163], a[80:83], v[2:17]
  ds_read_b64_tr_b16 a[184:185], v136 offset:40960
  ds_read_b64_tr_b16 a[186:187], v136 offset:41984
  v_mfma_f32_16x16x32_bf16 v[170:173], v[166:169], a[160:163], v[170:173]
  v_mfma_f32_16x16x32_bf16 v[178:181], v[166:169], a[80:83], v[178:181]
  v_mfma_f32_32x32x16_bf16 v[18:33], a[164:167], a[80:83], v[18:33]
  s_waitcnt lgkmcnt(6)
  ds_read_b64_tr_b16 a[188:189], v137 offset:40960
  ds_read_b64_tr_b16 a[190:191], v137 offset:41984
  s_add_u32 m0, s55, 0
  s_mul_i32 s53, s64, 256
  buffer_load_dwordx4 v150, s[24:27], s53 offen offset:0 lds
  v_mfma_f32_4x4x4_16b_bf16 v[182:185], a[80:81], a[80:81], v[182:185]
  v_mfma_f32_4x4x4_16b_bf16 v[186:189], a[82:83], a[82:83], v[186:189]
  v_mfma_f32_32x32x16_bf16 v[2:17], a[168:171], a[84:87], v[2:17]
  s_waitcnt vmcnt(5)
  s_barrier
  ds_read_b128 a[96:99], v146 offset:8192
  ds_read_b128 a[100:103], v147 offset:8192
  ds_read_b64_tr_b16 a[160:161], v138 offset:0
  ds_read_b64_tr_b16 a[162:163], v138 offset:1024
  buffer_load_dwordx4 v151, s[24:27], s53 offen offset:1024 lds
  v_mfma_f32_16x16x32_bf16 v[178:181], v[166:169], a[84:87], v[178:181]
  v_mfma_f32_32x32x16_bf16 v[18:33], a[172:175], a[84:87], v[18:33]
  s_waitcnt lgkmcnt(8)
  ds_read_b128 a[104:107], v148 offset:8192
  ds_read_b128 a[108:111], v149 offset:8192
  ds_read_b64_tr_b16 a[164:165], v139 offset:0
  ds_read_b64_tr_b16 a[166:167], v139 offset:1024
  buffer_load_dwordx4 v152, s[24:27], s53 offen offset:2048 lds
  v_mfma_f32_4x4x4_16b_bf16 v[182:185], a[84:85], a[84:85], v[182:185]
  v_mfma_f32_4x4x4_16b_bf16 v[186:189], a[86:87], a[86:87], v[186:189]
  v_mfma_f32_32x32x16_bf16 v[2:17], a[176:179], a[88:91], v[2:17]
  ds_read_b64_tr_b16 a[168:169], v142 offset:0
  ds_read_b64_tr_b16 a[170:171], v142 offset:1024
  buffer_load_dwordx4 v153, s[24:27], s53 offen offset:3072 lds
  v_mfma_f32_16x16x32_bf16 v[170:173], v[166:169], a[176:179], v[170:173]
  v_mfma_f32_16x16x32_bf16 v[178:181], v[166:169], a[88:91], v[178:181]
  v_mfma_f32_32x32x16_bf16 v[18:33], a[180:183], a[88:91], v[18:33]
  s_waitcnt lgkmcnt(10)
  ds_read_b64_tr_b16 a[172:173], v143 offset:0
  ds_read_b64_tr_b16 a[174:175], v143 offset:1024
  v_mfma_f32_4x4x4_16b_bf16 v[182:185], a[88:89], a[88:89], v[182:185]
  v_mfma_f32_4x4x4_16b_bf16 v[186:189], a[90:91], a[90:91], v[186:189]
  v_mfma_f32_32x32x16_bf16 v[2:17], a[184:187], a[92:95], v[2:17]
  ds_read_b64_tr_b16 a[176:177], v138 offset:8192
  ds_read_b64_tr_b16 a[178:179], v138 offset:9216
  s_add_u32 m0, s56, 65536
  s_mul_i32 s54, s64, 442368
  buffer_load_dwordx4 v154, s[28:31], s54 offen offset:0 lds
  v_mfma_f32_16x16x32_bf16 v[178:181], v[166:169], a[92:95], v[178:181]
  v_mfma_f32_32x32x16_bf16 v[18:33], a[188:191], a[92:95], v[18:33]
  s_waitcnt lgkmcnt(6)
  ds_read_b64_tr_b16 a[180:181], v139 offset:8192
  ds_read_b64_tr_b16 a[182:183], v139 offset:9216
  buffer_load_dwordx4 v155, s[28:31], s54 offen offset:1024 lds
  v_mfma_f32_4x4x4_16b_bf16 v[182:185], a[92:93], a[92:93], v[182:185]
  v_mfma_f32_4x4x4_16b_bf16 v[186:189], a[94:95], a[94:95], v[186:189]
  v_mfma_f32_32x32x16_bf16 v[2:17], a[160:163], a[96:99], v[2:17]
  ds_read_b64_tr_b16 a[184:185], v142 offset:8192
  ds_read_b64_tr_b16 a[186:187], v142 offset:9216
  buffer_load_dwordx4 v156, s[28:31], s54 offen offset:2048 lds
  v_mfma_f32_16x16x32_bf16 v[170:173], v[166:169], a[160:163], v[170:173]
  v_mfma_f32_16x16x32_bf16 v[178:181], v[166:169], a[96:99], v[178:181]
  v_mfma_f32_32x32x16_bf16 v[18:33], a[164:167], a[96:99], v[18:33]
  s_waitcnt lgkmcnt(6)
  ds_read_b64_tr_b16 a[188:189], v143 offset:8192
  ds_read_b64_tr_b16 a[190:191], v143 offset:9216
  buffer_load_dwordx4 v157, s[28:31], s54 offen offset:3072 lds
  v_mfma_f32_4x4x4_16b_bf16 v[182:185], a[96:97], a[96:97], v[182:185]
  v_mfma_f32_4x4x4_16b_bf16 v[186:189], a[98:99], a[98:99], v[186:189]
  v_mfma_f32_32x32x16_bf16 v[2:17], a[168:171], a[100:103], v[2:17]
  s_waitcnt vmcnt(8)
  ds_read_b128 a[112:115], v146 offset:12288
  ds_read_b128 a[116:119], v147 offset:12288
  ds_read_b64_tr_b16 a[160:161], v140 offset:0
  ds_read_b64_tr_b16 a[162:163], v140 offset:1024
  v_mfma_f32_16x16x32_bf16 v[178:181], v[166:169], a[100:103], v[178:181]
  v_mfma_f32_32x32x16_bf16 v[18:33], a[172:175], a[100:103], v[18:33]
  s_waitcnt lgkmcnt(8)
  ds_read_b128 a[120:123], v148 offset:12288
  ds_read_b128 a[124:127], v149 offset:12288
  ds_read_b64_tr_b16 a[164:165], v141 offset:0
  ds_read_b64_tr_b16 a[166:167], v141 offset:1024
  s_add_u32 m0, s55, 4096
  s_add_u32 s53, s53, 128
  buffer_load_dwordx4 v150, s[24:27], s53 offen offset:0 lds
  v_mfma_f32_4x4x4_16b_bf16 v[182:185], a[100:101], a[100:101], v[182:185]
  v_mfma_f32_4x4x4_16b_bf16 v[186:189], a[102:103], a[102:103], v[186:189]
  v_mfma_f32_32x32x16_bf16 v[2:17], a[176:179], a[104:107], v[2:17]
  ds_read_b64_tr_b16 a[168:169], v144 offset:0
  ds_read_b64_tr_b16 a[170:171], v144 offset:1024
  buffer_load_dwordx4 v151, s[24:27], s53 offen offset:1024 lds
  v_mfma_f32_16x16x32_bf16 v[170:173], v[166:169], a[176:179], v[170:173]
  v_mfma_f32_16x16x32_bf16 v[178:181], v[166:169], a[104:107], v[178:181]
  v_mfma_f32_32x32x16_bf16 v[18:33], a[180:183], a[104:107], v[18:33]
  s_waitcnt lgkmcnt(10)
  ds_read_b64_tr_b16 a[172:173], v145 offset:0
  ds_read_b64_tr_b16 a[174:175], v145 offset:1024
  buffer_load_dwordx4 v152, s[24:27], s53 offen offset:2048 lds
  v_mfma_f32_4x4x4_16b_bf16 v[182:185], a[104:105], a[104:105], v[182:185]
  v_mfma_f32_4x4x4_16b_bf16 v[186:189], a[106:107], a[106:107], v[186:189]
  v_mfma_f32_32x32x16_bf16 v[2:17], a[184:187], a[108:111], v[2:17]
  ds_read_b64_tr_b16 a[176:177], v140 offset:8192
  ds_read_b64_tr_b16 a[178:179], v140 offset:9216
  buffer_load_dwordx4 v153, s[24:27], s53 offen offset:3072 lds
  v_mfma_f32_16x16x32_bf16 v[178:181], v[166:169], a[108:111], v[178:181]
  v_mfma_f32_32x32x16_bf16 v[18:33], a[188:191], a[108:111], v[18:33]
  s_waitcnt lgkmcnt(6)
  ds_read_b64_tr_b16 a[180:181], v141 offset:8192
  ds_read_b64_tr_b16 a[182:183], v141 offset:9216
  v_mfma_f32_4x4x4_16b_bf16 v[182:185], a[108:109], a[108:109], v[182:185]
  v_mfma_f32_4x4x4_16b_bf16 v[186:189], a[110:111], a[110:111], v[186:189]
  v_mfma_f32_32x32x16_bf16 v[2:17], a[160:163], a[112:115], v[2:17]
  ds_read_b64_tr_b16 a[184:185], v144 offset:8192
  ds_read_b64_tr_b16 a[186:187], v144 offset:9216
  s_add_u32 m0, s56, 81920
  s_mul_i32 s54, s60, 442368
  buffer_load_dwordx4 v158, s[28:31], s54 offen offset:0 lds
  v_mfma_f32_16x16x32_bf16 v[170:173], v[166:169], a[160:163], v[170:173]
  v_mfma_f32_16x16x32_bf16 v[178:181], v[166:169], a[112:115], v[178:181]
  v_mfma_f32_32x32x16_bf16 v[18:33], a[164:167], a[112:115], v[18:33]
  s_waitcnt lgkmcnt(6)
  ds_read_b64_tr_b16 a[188:189], v145 offset:8192
  ds_read_b64_tr_b16 a[190:191], v145 offset:9216
  buffer_load_dwordx4 v159, s[28:31], s54 offen offset:1024 lds
  v_mfma_f32_4x4x4_16b_bf16 v[182:185], a[112:113], a[112:113], v[182:185]
  v_mfma_f32_4x4x4_16b_bf16 v[186:189], a[114:115], a[114:115], v[186:189]
  v_mfma_f32_32x32x16_bf16 v[2:17], a[168:171], a[116:119], v[2:17]
  s_waitcnt vmcnt(6)
  s_barrier
  ds_read_b128 a[128:131], v146 offset:0
  ds_read_b128 a[132:135], v147 offset:0
  ds_read_b64_tr_b16 a[160:161], v138 offset:16384
  ds_read_b64_tr_b16 a[162:163], v138 offset:17408
  buffer_load_dwordx4 v160, s[28:31], s54 offen offset:2048 lds
  v_mfma_f32_16x16x32_bf16 v[178:181], v[166:169], a[116:119], v[178:181]
  v_mfma_f32_32x32x16_bf16 v[18:33], a[172:175], a[116:119], v[18:33]
  s_waitcnt lgkmcnt(8)
  ds_read_b128 a[136:139], v148 offset:0
  ds_read_b128 a[140:143], v149 offset:0
  ds_read_b64_tr_b16 a[164:165], v139 offset:16384
  ds_read_b64_tr_b16 a[166:167], v139 offset:17408
  buffer_load_dwordx4 v161, s[28:31], s54 offen offset:3072 lds
  v_mfma_f32_4x4x4_16b_bf16 v[182:185], a[116:117], a[116:117], v[182:185]
  v_mfma_f32_4x4x4_16b_bf16 v[186:189], a[118:119], a[118:119], v[186:189]
  v_mfma_f32_32x32x16_bf16 v[2:17], a[176:179], a[120:123], v[2:17]
  ds_read_b64_tr_b16 a[168:169], v142 offset:16384
  ds_read_b64_tr_b16 a[170:171], v142 offset:17408
  v_mfma_f32_16x16x32_bf16 v[170:173], v[166:169], a[176:179], v[170:173]
  v_mfma_f32_16x16x32_bf16 v[178:181], v[166:169], a[120:123], v[178:181]
  v_mfma_f32_32x32x16_bf16 v[18:33], a[180:183], a[120:123], v[18:33]
  s_waitcnt lgkmcnt(10)
  ds_read_b64_tr_b16 a[172:173], v143 offset:16384
  ds_read_b64_tr_b16 a[174:175], v143 offset:17408
  s_add_u32 m0, s56, 0
  s_mul_i32 s54, s61, 442368
  buffer_load_dwordx4 v158, s[28:31], s54 offen offset:0 lds
  v_mfma_f32_4x4x4_16b_bf16 v[182:185], a[120:121], a[120:121], v[182:185]
  v_mfma_f32_4x4x4_16b_bf16 v[186:189], a[122:123], a[122:123], v[186:189]
  v_mfma_f32_32x32x16_bf16 v[2:17], a[184:187], a[124:127], v[2:17]
  ds_read_b64_tr_b16 a[176:177], v138 offset:24576
  ds_read_b64_tr_b16 a[178:179], v138 offset:25600
  buffer_load_dwordx4 v159, s[28:31], s54 offen offset:1024 lds
  v_mfma_f32_16x16x32_bf16 v[178:181], v[166:169], a[124:127], v[178:181]
  v_mfma_f32_32x32x16_bf16 v[18:33], a[188:191], a[124:127], v[18:33]
  s_waitcnt lgkmcnt(6)
  ds_read_b64_tr_b16 a[180:181], v139 offset:24576
  ds_read_b64_tr_b16 a[182:183], v139 offset:25600
  buffer_load_dwordx4 v160, s[28:31], s54 offen offset:2048 lds
  v_mfma_f32_4x4x4_16b_bf16 v[182:185], a[124:125], a[124:125], v[182:185]
  v_mfma_f32_4x4x4_16b_bf16 v[186:189], a[126:127], a[126:127], v[186:189]
  v_mfma_f32_32x32x16_bf16 v[2:17], a[160:163], a[128:131], v[2:17]
  ds_read_b64_tr_b16 a[184:185], v142 offset:24576
  ds_read_b64_tr_b16 a[186:187], v142 offset:25600
  buffer_load_dwordx4 v161, s[28:31], s54 offen offset:3072 lds
  v_mfma_f32_16x16x32_bf16 v[170:173], v[166:169], a[160:163], v[170:173]
  v_mfma_f32_16x16x32_bf16 v[178:181], v[166:169], a[128:131], v[178:181]
  v_mfma_f32_32x32x16_bf16 v[18:33], a[164:167], a[128:131], v[18:33]
  s_waitcnt lgkmcnt(6)
  ds_read_b64_tr_b16 a[188:189], v143 offset:24576
  ds_read_b64_tr_b16 a[190:191], v143 offset:25600
  v_mfma_f32_4x4x4_16b_bf16 v[182:185], a[128:129], a[128:129], v[182:185]
  v_mfma_f32_4x4x4_16b_bf16 v[186:189], a[130:131], a[130:131], v[186:189]
  v_mfma_f32_32x32x16_bf16 v[2:17], a[168:171], a[132:135], v[2:17]
  s_waitcnt vmcnt(8)
  ds_read_b128 a[144:147], v146 offset:4096
  ds_read_b128 a[148:151], v147 offset:4096
  ds_read_b64_tr_b16 a[160:161], v140 offset:16384
  ds_read_b64_tr_b16 a[162:163], v140 offset:17408
  s_add_u32 m0, s56, 16384
  s_mul_i32 s54, s62, 442368
  buffer_load_dwordx4 v158, s[28:31], s54 offen offset:0 lds
  v_mfma_f32_16x16x32_bf16 v[178:181], v[166:169], a[132:135], v[178:181]
  v_mfma_f32_32x32x16_bf16 v[18:33], a[172:175], a[132:135], v[18:33]
  s_waitcnt lgkmcnt(8)
  ds_read_b128 a[152:155], v148 offset:4096
  ds_read_b128 a[156:159], v149 offset:4096
  ds_read_b64_tr_b16 a[164:165], v141 offset:16384
  ds_read_b64_tr_b16 a[166:167], v141 offset:17408
  buffer_load_dwordx4 v159, s[28:31], s54 offen offset:1024 lds
  v_mfma_f32_4x4x4_16b_bf16 v[182:185], a[132:133], a[132:133], v[182:185]
  v_mfma_f32_4x4x4_16b_bf16 v[186:189], a[134:135], a[134:135], v[186:189]
  v_mfma_f32_32x32x16_bf16 v[2:17], a[176:179], a[136:139], v[2:17]
  ds_read_b64_tr_b16 a[168:169], v144 offset:16384
  ds_read_b64_tr_b16 a[170:171], v144 offset:17408
  buffer_load_dwordx4 v160, s[28:31], s54 offen offset:2048 lds
  s_mul_i32 s52, s57, 55296
  v_mfma_f32_16x16x32_bf16 v[170:173], v[166:169], a[176:179], v[170:173]
  s_add_u32 s52, s52, 8388608
  s_xor_b32 s50, s47, 0
  v_mfma_f32_16x16x32_bf16 v[178:181], v[166:169], a[136:139], v[178:181]
  v_mfma_f32_32x32x16_bf16 v[18:33], a[180:183], a[136:139], v[18:33]
  s_waitcnt lgkmcnt(10)
  ds_read_b64_tr_b16 a[172:173], v145 offset:16384
  ds_read_b64_tr_b16 a[174:175], v145 offset:17408
  buffer_load_dwordx4 v161, s[28:31], s54 offen offset:3072 lds
  s_lshl_b32 s51, s46, 1
  s_add_u32 s50, s50, s51
  v_mfma_f32_4x4x4_16b_bf16 v[182:185], a[136:137], a[136:137], v[182:185]
  v_mfma_f32_4x4x4_16b_bf16 v[186:189], a[138:139], a[138:139], v[186:189]
  v_mfma_f32_32x32x16_bf16 v[2:17], a[184:187], a[140:143], v[2:17]
  ds_read_b64_tr_b16 a[176:177], v140 offset:24576
  ds_read_b64_tr_b16 a[178:179], v140 offset:25600
  buffer_load_dword v226, v210, s[40:43], 0 offen
  s_sub_u32 s50, s50, 0
  s_mul_i32 s51, s50, 2048
  s_add_u32 s51, s51, s52
  v_mfma_f32_16x16x32_bf16 v[178:181], v[166:169], a[140:143], v[178:181]
  v_mfma_f32_32x32x16_bf16 v[18:33], a[188:191], a[140:143], v[18:33]
  s_waitcnt lgkmcnt(6)
  ds_read_b64_tr_b16 a[180:181], v141 offset:24576
  ds_read_b64_tr_b16 a[182:183], v141 offset:25600
  s_add_u32 m0, s56, 32768
  s_mul_i32 s54, s63, 442368
  buffer_load_dwordx4 v158, s[28:31], s54 offen offset:0 lds
  v_mfma_f32_4x4x4_16b_bf16 v[182:185], a[140:141], a[140:141], v[182:185]
  v_mfma_f32_4x4x4_16b_bf16 v[186:189], a[142:143], a[142:143], v[186:189]
  v_mfma_f32_32x32x16_bf16 v[2:17], a[160:163], a[144:147], v[2:17]
  ds_read_b64_tr_b16 a[184:185], v144 offset:24576
  ds_read_b64_tr_b16 a[186:187], v144 offset:25600
  buffer_load_dwordx4 v159, s[28:31], s54 offen offset:1024 lds
  s_cmp_lt_u32 s50, 27
  s_cselect_b32 s51, s51, 2146435072
  v_add_u32 v152, s51, v199
  v_mfma_f32_16x16x32_bf16 v[170:173], v[166:169], a[160:163], v[170:173]
  s_xor_b32 s50, s47, 1
  s_lshl_b32 s51, s46, 1
  v_mfma_f32_16x16x32_bf16 v[178:181], v[166:169], a[144:147], v[178:181]
  v_mfma_f32_32x32x16_bf16 v[18:33], a[164:167], a[144:147], v[18:33]
  s_waitcnt lgkmcnt(6)
  ds_read_b64_tr_b16 a[188:189], v145 offset:24576
  ds_read_b64_tr_b16 a[190:191], v145 offset:25600
  buffer_load_dwordx4 v160, s[28:31], s54 offen offset:2048 lds
  s_add_u32 s50, s50, s51
  s_sub_u32 s50, s50, 0
  v_mfma_f32_4x4x4_16b_bf16 v[182:185], a[144:145], a[144:145], v[182:185]
  v_mfma_f32_4x4x4_16b_bf16 v[186:189], a[146:147], a[146:147], v[186:189]
  v_mfma_f32_32x32x16_bf16 v[2:17], a[168:171], a[148:151], v[2:17]
  s_waitcnt vmcnt(12)
  s_barrier
  ds_read_b64_tr_b16 a[160:161], v138 offset:32768
  ds_read_b64_tr_b16 a[162:163], v138 offset:33792
  buffer_load_dwordx4 v161, s[28:31], s54 offen offset:3072 lds
  s_mul_i32 s51, s50, 2048
  v_mfma_f32_16x16x32_bf16 v[178:181], v[166:169], a[148:151], v[178:181]
  v_mfma_f32_32x32x16_bf16 v[18:33], a[172:175], a[148:151], v[18:33]
  s_waitcnt lgkmcnt(6)
  ds_read_b64_tr_b16 a[164:165], v139 offset:32768
  ds_read_b64_tr_b16 a[166:167], v139 offset:33792
  s_add_u32 s51, s51, s52
  s_cmp_lt_u32 s50, 27
  s_cselect_b32 s51, s51, 2146435072
  v_add_u32 v153, s51, v199
  v_mfma_f32_4x4x4_16b_bf16 v[182:185], a[148:149], a[148:149], v[182:185]
  v_mfma_f32_4x4x4_16b_bf16 v[186:189], a[150:151], a[150:151], v[186:189]
  v_mfma_f32_32x32x16_bf16 v[2:17], a[176:179], a[152:155], v[2:17]
  ds_read_b64_tr_b16 a[168:169], v142 offset:32768
  ds_read_b64_tr_b16 a[170:171], v142 offset:33792
  s_add_u32 m0, s56, 49152
  s_mul_i32 s54, s64, 442368
  buffer_load_dwordx4 v158, s[28:31], s54 offen offset:0 lds
  s_lshl_b32 s52, s57, 11
  v_mfma_f32_16x16x32_bf16 v[170:173], v[166:169], a[176:179], v[170:173]
  s_add_u32 s52, s52, 12648448
  s_xor_b32 s50, s47, 0
  v_mfma_f32_16x16x32_bf16 v[178:181], v[166:169], a[152:155], v[178:181]
  v_mfma_f32_32x32x16_bf16 v[18:33], a[180:183], a[152:155], v[18:33]
  s_waitcnt lgkmcnt(6)
  ds_read_b64_tr_b16 a[172:173], v143 offset:32768
  ds_read_b64_tr_b16 a[174:175], v143 offset:33792
  buffer_load_dwordx4 v159, s[28:31], s54 offen offset:1024 lds
  s_lshl_b32 s51, s46, 1
  s_add_u32 s50, s50, s51
  v_mfma_f32_4x4x4_16b_bf16 v[182:185], a[152:153], a[152:153], v[182:185]
  v_mfma_f32_4x4x4_16b_bf16 v[186:189], a[154:155], a[154:155], v[186:189]
  v_mfma_f32_32x32x16_bf16 v[2:17], a[184:187], a[156:159], v[2:17]
  ds_read_b64_tr_b16 a[176:177], v138 offset:40960
  ds_read_b64_tr_b16 a[178:179], v138 offset:41984
  buffer_load_dwordx4 v160, s[28:31], s54 offen offset:2048 lds
  s_sub_u32 s50, s50, 1
  s_mul_i32 s51, s50, 131072
  s_add_u32 s51, s51, s52
  v_mfma_f32_16x16x32_bf16 v[178:181], v[166:169], a[156:159], v[178:181]
  v_mfma_f32_32x32x16_bf16 v[18:33], a[188:191], a[156:159], v[18:33]
  s_waitcnt lgkmcnt(6)
  ds_read_b64_tr_b16 a[180:181], v139 offset:40960
  ds_read_b64_tr_b16 a[182:183], v139 offset:41984
  buffer_load_dwordx4 v161, s[28:31], s54 offen offset:3072 lds
  s_cmp_lt_u32 s50, 27
  s_cselect_b32 s51, s51, 2146435072
  v_mfma_f32_4x4x4_16b_bf16 v[182:185], a[156:157], a[156:157], v[182:185]
  v_mfma_f32_4x4x4_16b_bf16 v[186:189], a[158:159], a[158:159], v[186:189]
  v_mfma_f32_32x32x16_bf16 v[34:49], a[160:163], a[0:3], 0
  ds_read_b64_tr_b16 a[184:185], v142 offset:40960
  ds_read_b64_tr_b16 a[186:187], v142 offset:41984
  v_add_u32 v150, s51, v199
  s_xor_b32 s50, s47, 1
  s_lshl_b32 s51, s46, 1
  s_add_u32 s50, s50, s51
  s_sub_u32 s50, s50, 1
  v_mfma_f32_16x16x32_bf16 v[174:177], v[166:169], a[160:163], 0
  s_mul_i32 s51, s50, 131072
  s_add_u32 s51, s51, s52
  v_mfma_f32_32x32x16_bf16 v[50:65], a[164:167], a[0:3], 0
  s_waitcnt lgkmcnt(6)
  ds_read_b64_tr_b16 a[188:189], v143 offset:40960
  ds_read_b64_tr_b16 a[190:191], v143 offset:41984
  v_cvt_pk_bf16_f32 v171, v170, v170
  v_and_b32 v172, 0xffff0000, v171
  v_sub_f32 v172, v170, v172
  v_cvt_pk_bf16_f32 v170, v170, v172
  v_and_b32 v171, 0xffff, v171
  v_mfma_f32_32x32x16_bf16 v[34:49], a[168:171], a[4:7], v[34:49]
  ds_write_b64 v207, v[170:171] offset:0
  ds_read_b64_tr_b16 a[160:161], v140 offset:32768
  ds_read_b64_tr_b16 a[162:163], v140 offset:33792
  s_cmp_lt_u32 s50, 27
  s_cselect_b32 s51, s51, 2146435072
  v_add_u32 v151, s51, v199
  v_mfma_f32_32x32x16_bf16 v[50:65], a[172:175], a[4:7], v[50:65]
  s_waitcnt lgkmcnt(7)
  ds_read_b64_tr_b16 a[164:165], v141 offset:32768
  ds_read_b64_tr_b16 a[166:167], v141 offset:33792
  s_mul_i32 s52, s57, 81920
  s_lshl_b32 s50, s46, 12
  s_add_u32 s52, s52, s50
  s_lshl_b32 s50, s47, 11
  v_mfma_f32_32x32x16_bf16 v[34:49], a[176:179], a[8:11], v[34:49]
  ds_read_b64_tr_b16 a[168:169], v144 offset:32768
  ds_read_b64_tr_b16 a[170:171], v144 offset:33792
  v_add_u32 v220, s52, v199
  v_xor_b32 v220, s50, v220
  v_xor_b32 v221, 2048, v220
  v_add_f32 v182, v182, v186
  v_add_f32 v183, v183, v187
  v_mfma_f32_16x16x32_bf16 v[174:177], v[166:169], a[176:179], v[174:177]
  v_add_f32 v184, v184, v188
  v_add_f32 v185, v185, v189
  v_mfma_f32_32x32x16_bf16 v[50:65], a[180:183], a[8:11], v[50:65]
  s_waitcnt lgkmcnt(6)
  s_barrier
  ds_read_b64 v[192:193], v196 offset:0
  ds_read_b64 v[194:195], v197 offset:0
  ds_read_b64_tr_b16 a[172:173], v145 offset:32768
  ds_read_b64_tr_b16 a[174:175], v145 offset:33792
  v_and_b32 v216, 3, v198
  v_mfma_f32_32x32x16_bf16 v[34:49], a[184:187], a[12:15], v[34:49]
  ds_read_b64_tr_b16 a[176:177], v140 offset:40960
  ds_read_b64_tr_b16 a[178:179], v140 offset:41984
  v_cmp_eq_u32 vcc, 1, v216
  v_mul_f32 v217, 0xbacccccd, v178
  v_cvt_pk_bf16_f32 v190, v217, v217
  v_cndmask_b32 v182, v182, v183, vcc
  v_cmp_eq_u32 vcc, 2, v216
  v_mfma_f32_32x32x16_bf16 v[50:65], a[188:191], a[12:15], v[50:65]
  s_waitcnt lgkmcnt(8)
  ds_read_b64_tr_b16 a[180:181], v141 offset:40960
  ds_read_b64_tr_b16 a[182:183], v141 offset:41984
  v_and_b32 v219, 0xffff0000, v190
  v_sub_f32 v219, v217, v219
  v_cndmask_b32 v182, v182, v184, vcc
  v_cmp_eq_u32 vcc, 3, v216
  v_mfma_f32_32x32x16_bf16 v[34:49], a[160:163], a[16:19], v[34:49]
  s_waitcnt lgkmcnt(6)
  ds_read_b64_tr_b16 a[184:185], v144 offset:40960
  ds_read_b64_tr_b16 a[186:187], v144 offset:41984
  v_cvt_pk_bf16_f32 v191, v219, 0
  v_mul_f32 v217, v217, v217
  v_cndmask_b32 v182, v182, v185, vcc
  v_mov_b32 v218, v182
  v_mfma_f32_16x16x32_bf16 v[174:177], v[166:169], a[160:163], v[174:177]
  s_mov_b32 s49, 0x3acccccd
  s_nop 0
  s_nop 1
  v_mfma_f32_32x32x8_bf16 v[2:17], v[192:193], v[190:191], v[2:17]
  v_permlane32_swap_b32 v218, v182
  s_nop 1
  v_add_f32 v218, v218, v182
  v_fma_f32 v218, v218, s49, -v217
  v_max_f32 v218, 0, v218
  v_mfma_f32_32x32x16_bf16 v[50:65], a[164:167], a[16:19], v[50:65]
  s_waitcnt lgkmcnt(6)
  ds_read_b64_tr_b16 a[188:189], v145 offset:40960
  ds_read_b64_tr_b16 a[190:191], v145 offset:41984
  v_add_f32 v218, 0x3727c5ac, v218
  v_rsq_f32 v203, v218
  s_nop 0
  v_mul_f32 v202, v218, v203
  s_nop 1
  v_mfma_f32_32x32x8_bf16 v[18:33], v[194:195], v[190:191], v[18:33]
  v_mul_f32 v200, 0xc0135761, v203
  v_mul_f32 v201, v203, v203
  v_mul_f32 v201, v200, v201
  v_mul_f32 v201, 0x3d372713, v201
  v_mfma_f32_32x32x16_bf16 v[34:49], a[168:171], a[20:23], v[34:49]
  s_waitcnt vmcnt(13)
  s_barrier
  ds_read_b64_tr_b16 a[160:161], v130 offset:0
  ds_read_b64_tr_b16 a[162:163], v130 offset:1024
  s_cmp_lt_u32 s46, 10
  s_cselect_b32 s49, 0x3ea52b5c, 1.0
  v_mul_f32 v211, s49, v203
  v_mfma_f32_32x32x16_bf16 v[50:65], a[172:175], a[20:23], v[50:65]
  s_waitcnt lgkmcnt(6)
  ds_read_b64_tr_b16 a[164:165], v131 offset:0
  ds_read_b64_tr_b16 a[166:167], v131 offset:1024
  v_mfma_f32_32x32x16_bf16 v[34:49], a[176:179], a[24:27], v[34:49]
  ds_read_b64_tr_b16 a[168:169], v134 offset:0
  ds_read_b64_tr_b16 a[170:171], v134 offset:1024
  s_add_u32 m0, s56, 65536
  s_mul_i32 s54, s60, 491520
  buffer_load_dwordx4 v162, s[32:35], s54 offen offset:0 lds
  v_mfma_f32_16x16x32_bf16 v[174:177], v[166:169], a[176:179], v[174:177]
  v_mfma_f32_32x32x16_bf16 v[50:65], a[180:183], a[24:27], v[50:65]
  s_waitcnt lgkmcnt(6)
  ds_read_b64_tr_b16 a[172:173], v135 offset:0
  ds_read_b64_tr_b16 a[174:175], v135 offset:1024
  v_mul_f32 v216, v2, v2
  v_mul_f32 v217, v3, v3
  v_mul_f32 v218, v4, v4
  v_mul_f32 v219, v5, v5
  v_mfma_f32_32x32x16_bf16 v[34:49], a[184:187], a[28:31], v[34:49]
  ds_read_b64_tr_b16 a[176:177], v130 offset:8192
  ds_read_b64_tr_b16 a[178:179], v130 offset:9216
  v_fma_f32 v216, v216, v201, v200
  v_fma_f32 v217, v217, v201, v200
  v_fma_f32 v218, v218, v201, v200
  v_fma_f32 v219, v219, v201, v200
  v_mul_f32 v216, v216, v2
  v_mfma_f32_32x32x16_bf16 v[50:65], a[188:191], a[28:31], v[50:65]
  s_waitcnt lgkmcnt(6)
  ds_read_b64_tr_b16 a[180:181], v131 offset:8192
  ds_read_b64_tr_b16 a[182:183], v131 offset:9216
  v_mul_f32 v217, v217, v3
  v_mul_f32 v218, v218, v4
  v_mul_f32 v219, v219, v5
  v_mfma_f32_32x32x16_bf16 v[34:49], a[160:163], a[32:35], v[34:49]
  ds_read_b64_tr_b16 a[184:185], v134 offset:8192
  ds_read_b64_tr_b16 a[186:187], v134 offset:9216
  buffer_load_dwordx4 v163, s[32:35], s54 offen offset:1024 lds
  v_exp_f32 v216, v216
  v_mfma_f32_16x16x32_bf16 v[174:177], v[166:169], a[160:163], v[174:177]
  v_exp_f32 v217, v217
  v_mfma_f32_32x32x16_bf16 v[50:65], a[164:167], a[32:35], v[50:65]
  s_waitcnt lgkmcnt(6)
  ds_read_b64_tr_b16 a[188:189], v135 offset:8192
  ds_read_b64_tr_b16 a[190:191], v135 offset:9216
  v_exp_f32 v218, v218
  v_exp_f32 v219, v219
  v_mfma_f32_32x32x16_bf16 v[34:49], a[168:171], a[36:39], v[34:49]
  ds_read_b64_tr_b16 a[160:161], v132 offset:0
  ds_read_b64_tr_b16 a[162:163], v132 offset:1024
  v_fma_f32 v216, v216, v202, v202
  v_fma_f32 v217, v217, v202, v202
  v_fma_f32 v218, v218, v202, v202
  v_fma_f32 v219, v219, v202, v202
  v_mfma_f32_32x32x16_bf16 v[50:65], a[172:175], a[36:39], v[50:65]
  s_waitcnt lgkmcnt(6)
  ds_read_b64_tr_b16 a[164:165], v133 offset:0
  ds_read_b64_tr_b16 a[166:167], v133 offset:1024
  v_rcp_f32 v216, v216
  v_rcp_f32 v217, v217
  v_mfma_f32_32x32x16_bf16 v[34:49], a[176:179], a[40:43], v[34:49]
  ds_read_b64_tr_b16 a[168:169], v136 offset:0
  ds_read_b64_tr_b16 a[170:171], v136 offset:1024
  buffer_load_dwordx4 v164, s[32:35], s54 offen offset:2048 lds
  v_rcp_f32 v218, v218
  v_mfma_f32_16x16x32_bf16 v[174:177], v[166:169], a[176:179], v[174:177]
  v_rcp_f32 v219, v219
  v_mfma_f32_32x32x16_bf16 v[50:65], a[180:183], a[40:43], v[50:65]
  s_waitcnt lgkmcnt(6)
  ds_read_b64_tr_b16 a[172:173], v137 offset:0
  ds_read_b64_tr_b16 a[174:175], v137 offset:1024
  v_mul_f32 v2, v2, v216
  v_mul_f32 v3, v3, v217
  v_mul_f32 v4, v4, v218
  v_mul_f32 v5, v5, v219
  v_mfma_f32_32x32x16_bf16 v[34:49], a[184:187], a[44:47], v[34:49]
  ds_read_b64_tr_b16 a[176:177], v132 offset:8192
  ds_read_b64_tr_b16 a[178:179], v132 offset:9216
  v_add_f32 v204, v204, v2
  v_fmac_f32 v205, v2, v2
  v_add_f32 v204, v204, v3
  v_fmac_f32 v205, v3, v3
  v_add_f32 v204, v204, v4
  v_mfma_f32_32x32x16_bf16 v[50:65], a[188:191], a[44:47], v[50:65]
  s_waitcnt lgkmcnt(6)
  ds_read_b64_tr_b16 a[180:181], v133 offset:8192
  ds_read_b64_tr_b16 a[182:183], v133 offset:9216
  v_fmac_f32 v205, v4, v4
  v_add_f32 v204, v204, v5
  v_fmac_f32 v205, v5, v5
  v_mul_f32 v216, v6, v6
  v_mfma_f32_32x32x16_bf16 v[34:49], a[160:163], a[48:51], v[34:49]
  ds_read_b64_tr_b16 a[184:185], v136 offset:8192
  ds_read_b64_tr_b16 a[186:187], v136 offset:9216
  buffer_load_dwordx4 v165, s[32:35], s54 offen offset:3072 lds
  v_mul_f32 v217, v7, v7
  v_mul_f32 v218, v8, v8
  v_mul_f32 v219, v9, v9
  v_mfma_f32_16x16x32_bf16 v[174:177], v[166:169], a[160:163], v[174:177]
  v_fma_f32 v216, v216, v201, v200
  v_fma_f32 v217, v217, v201, v200
  v_mfma_f32_32x32x16_bf16 v[50:65], a[164:167], a[48:51], v[50:65]
  s_waitcnt lgkmcnt(6)
  ds_read_b64_tr_b16 a[188:189], v137 offset:8192
  ds_read_b64_tr_b16 a[190:191], v137 offset:9216
  v_fma_f32 v218, v218, v201, v200
  v_fma_f32 v219, v219, v201, v200
  v_mul_f32 v216, v216, v6
  v_mul_f32 v217, v217, v7
  v_mfma_f32_32x32x16_bf16 v[34:49], a[168:171], a[52:55], v[34:49]
  s_waitcnt vmcnt(13)
  s_barrier
  ds_read_b64_tr_b16 a[160:161], v130 offset:16384
  ds_read_b64_tr_b16 a[162:163], v130 offset:17408
  v_mul_f32 v218, v218, v8
  v_mul_f32 v219, v219, v9
  v_mfma_f32_32x32x16_bf16 v[50:65], a[172:175], a[52:55], v[50:65]
  s_waitcnt lgkmcnt(6)
  ds_read_b64_tr_b16 a[164:165], v131 offset:16384
  ds_read_b64_tr_b16 a[166:167], v131 offset:17408
  v_exp_f32 v216, v216
  v_exp_f32 v217, v217
  v_mfma_f32_32x32x16_bf16 v[34:49], a[176:179], a[56:59], v[34:49]
  ds_read_b64_tr_b16 a[168:169], v134 offset:16384
  ds_read_b64_tr_b16 a[170:171], v134 offset:17408
  s_add_u32 m0, s56, 81920
  s_mul_i32 s54, s61, 491520
  buffer_load_dwordx4 v162, s[32:35], s54 offen offset:0 lds
  v_mfma_f32_16x16x32_bf16 v[174:177], v[166:169], a[176:179], v[174:177]
  v_exp_f32 v218, v218
  v_mfma_f32_32x32x16_bf16 v[50:65], a[180:183], a[56:59], v[50:65]
  s_waitcnt lgkmcnt(6)
  ds_read_b64_tr_b16 a[172:173], v135 offset:16384
  ds_read_b64_tr_b16 a[174:175], v135 offset:17408
  v_exp_f32 v219, v219
  v_fma_f32 v216, v216, v202, v202
  v_fma_f32 v217, v217, v202, v202
  v_mfma_f32_32x32x16_bf16 v[34:49], a[184:187], a[60:63], v[34:49]
  ds_read_b64_tr_b16 a[176:177], v130 offset:24576
  ds_read_b64_tr_b16 a[178:179], v130 offset:25600
  v_fma_f32 v218, v218, v202, v202
  v_fma_f32 v219, v219, v202, v202
  v_rcp_f32 v216, v216
  v_mfma_f32_32x32x16_bf16 v[50:65], a[188:191], a[60:63], v[50:65]
  s_waitcnt lgkmcnt(6)
  ds_read_b64_tr_b16 a[180:181], v131 offset:24576
  ds_read_b64_tr_b16 a[182:183], v131 offset:25600
  v_rcp_f32 v217, v217
  v_rcp_f32 v218, v218
  v_mfma_f32_32x32x16_bf16 v[34:49], a[160:163], a[64:67], v[34:49]
  ds_read_b64_tr_b16 a[184:185], v134 offset:24576
  ds_read_b64_tr_b16 a[186:187], v134 offset:25600
  buffer_load_dwordx4 v163, s[32:35], s54 offen offset:1024 lds
  v_rcp_f32 v219, v219
  v_mul_f32 v6, v6, v216
  v_mfma_f32_16x16x32_bf16 v[174:177], v[166:169], a[160:163], v[174:177]
  v_mul_f32 v7, v7, v217
  v_mul_f32 v8, v8, v218
  v_mfma_f32_32x32x16_bf16 v[50:65], a[164:167], a[64:67], v[50:65]
  s_waitcnt lgkmcnt(6)
  ds_read_b64_tr_b16 a[188:189], v135 offset:24576
  ds_read_b64_tr_b16 a[190:191], v135 offset:25600
  v_mul_f32 v9, v9, v219
  v_add_f32 v204, v204, v6
  v_fmac_f32 v205, v6, v6
  v_add_f32 v204, v204, v7
  v_mfma_f32_32x32x16_bf16 v[34:49], a[168:171], a[68:71], v[34:49]
  ds_read_b64_tr_b16 a[160:161], v132 offset:16384
  ds_read_b64_tr_b16 a[162:163], v132 offset:17408
  v_fmac_f32 v205, v7, v7
  v_add_f32 v204, v204, v8
  v_fmac_f32 v205, v8, v8
  v_add_f32 v204, v204, v9
  v_fmac_f32 v205, v9, v9
  v_mfma_f32_32x32x16_bf16 v[50:65], a[172:175], a[68:71], v[50:65]
  s_waitcnt lgkmcnt(6)
  ds_read_b64_tr_b16 a[164:165], v133 offset:16384
  ds_read_b64_tr_b16 a[166:167], v133 offset:17408
  v_mul_f32 v216, v10, v10
  v_mul_f32 v217, v11, v11
  v_mul_f32 v218, v12, v12
  v_mul_f32 v219, v13, v13
  v_mfma_f32_32x32x16_bf16 v[34:49], a[176:179], a[72:75], v[34:49]
  ds_read_b64_tr_b16 a[168:169], v136 offset:16384
  ds_read_b64_tr_b16 a[170:171], v136 offset:17408
  buffer_load_dwordx4 v164, s[32:35], s54 offen offset:2048 lds
  v_fma_f32 v216, v216, v201, v200
  v_fma_f32 v217, v217, v201, v200
  v_fma_f32 v218, v218, v201, v200
  v_mfma_f32_16x16x32_bf16 v[174:177], v[166:169], a[176:179], v[174:177]
  v_fma_f32 v219, v219, v201, v200
  v_mul_f32 v216, v216, v10
  v_mfma_f32_32x32x16_bf16 v[50:65], a[180:183], a[72:75], v[50:65]
  s_waitcnt lgkmcnt(6)
  ds_read_b64_tr_b16 a[172:173], v137 offset:16384
  ds_read_b64_tr_b16 a[174:175], v137 offset:17408
  v_mul_f32 v217, v217, v11
  v_mul_f32 v218, v218, v12
  v_mul_f32 v219, v219, v13
  v_mfma_f32_32x32x16_bf16 v[34:49], a[184:187], a[76:79], v[34:49]
  ds_read_b64_tr_b16 a[176:177], v132 offset:24576
  ds_read_b64_tr_b16 a[178:179], v132 offset:25600
  v_exp_f32 v216, v216
  v_exp_f32 v217, v217
  v_mfma_f32_32x32x16_bf16 v[50:65], a[188:191], a[76:79], v[50:65]
  s_waitcnt lgkmcnt(6)
  ds_read_b64_tr_b16 a[180:181], v133 offset:24576
  ds_read_b64_tr_b16 a[182:183], v133 offset:25600
  v_exp_f32 v218, v218
  v_exp_f32 v219, v219
  v_mfma_f32_32x32x16_bf16 v[34:49], a[160:163], a[80:83], v[34:49]
  ds_read_b64_tr_b16 a[184:185], v136 offset:24576
  ds_read_b64_tr_b16 a[186:187], v136 offset:25600
  buffer_load_dwordx4 v165, s[32:35], s54 offen offset:3072 lds
  v_fma_f32 v216, v216, v202, v202
  v_fma_f32 v217, v217, v202, v202
  v_fma_f32 v218, v218, v202, v202
  v_mfma_f32_16x16x32_bf16 v[174:177], v[166:169], a[160:163], v[174:177]
  v_fma_f32 v219, v219, v202, v202
  v_mfma_f32_32x32x16_bf16 v[50:65], a[164:167], a[80:83], v[50:65]
  s_waitcnt lgkmcnt(6)
  ds_read_b64_tr_b16 a[188:189], v137 offset:24576
  ds_read_b64_tr_b16 a[190:191], v137 offset:25600
  v_rcp_f32 v216, v216
  v_rcp_f32 v217, v217
  v_mfma_f32_32x32x16_bf16 v[34:49], a[168:171], a[84:87], v[34:49]
  s_waitcnt vmcnt(12)
  s_barrier
  ds_read_b64_tr_b16 a[160:161], v130 offset:32768
  ds_read_b64_tr_b16 a[162:163], v130 offset:33792
  v_rcp_f32 v218, v218
  v_mfma_f32_32x32x16_bf16 v[50:65], a[172:175], a[84:87], v[50:65]
  s_waitcnt lgkmcnt(6)
  ds_read_b64_tr_b16 a[164:165], v131 offset:32768
  ds_read_b64_tr_b16 a[166:167], v131 offset:33792
  v_rcp_f32 v219, v219
  v_mul_f32 v10, v10, v216
  v_mul_f32 v11, v11, v217
  v_mfma_f32_32x32x16_bf16 v[34:49], a[176:179], a[88:91], v[34:49]
  ds_read_b64_tr_b16 a[168:169], v134 offset:32768
  ds_read_b64_tr_b16 a[170:171], v134 offset:33792
  s_add_u32 m0, s56, 0
  s_mul_i32 s54, s62, 491520
  buffer_load_dwordx4 v162, s[32:35], s54 offen offset:0 lds
  v_mul_f32 v12, v12, v218
  v_mfma_f32_16x16x32_bf16 v[174:177], v[166:169], a[176:179], v[174:177]
  v_mul_f32 v13, v13, v219
  v_add_f32 v204, v204, v10
  v_mfma_f32_32x32x16_bf16 v[50:65], a[180:183], a[88:91], v[50:65]
  s_waitcnt lgkmcnt(6)
  ds_read_b64_tr_b16 a[172:173], v135 offset:32768
  ds_read_b64_tr_b16 a[174:175], v135 offset:33792
  v_fmac_f32 v205, v10, v10
  v_add_f32 v204, v204, v11
  v_fmac_f32 v205, v11, v11
  v_add_f32 v204, v204, v12
  v_mfma_f32_32x32x16_bf16 v[34:49], a[184:187], a[92:95], v[34:49]
  ds_read_b64_tr_b16 a[176:177], v130 offset:40960
  ds_read_b64_tr_b16 a[178:179], v130 offset:41984
  v_fmac_f32 v205, v12, v12
  v_add_f32 v204, v204, v13
  v_fmac_f32 v205, v13, v13
  v_mul_f32 v216, v14, v14
  v_mul_f32 v217, v15, v15
  v_mfma_f32_32x32x16_bf16 v[50:65], a[188:191], a[92:95], v[50:65]
  s_waitcnt lgkmcnt(6)
  ds_read_b64_tr_b16 a[180:181], v131 offset:40960
  ds_read_b64_tr_b16 a[182:183], v131 offset:41984
  v_mul_f32 v218, v16, v16
  v_mul_f32 v219, v17, v17
  v_fma_f32 v216, v216, v201, v200
  v_fma_f32 v217, v217, v201, v200
  v_mfma_f32_32x32x16_bf16 v[34:49], a[160:163], a[96:99], v[34:49]
  ds_read_b64_tr_b16 a[184:185], v134 offset:40960
  ds_read_b64_tr_b16 a[186:187], v134 offset:41984
  buffer_load_dwordx4 v163, s[32:35], s54 offen offset:1024 lds
  v_fma_f32 v218, v218, v201, v200
  v_fma_f32 v219, v219, v201, v200
  v_mul_f32 v216, v216, v14
  v_mfma_f32_16x16x32_bf16 v[174:177], v[166:169], a[160:163], v[174:177]
  v_mul_f32 v217, v217, v15
  v_mul_f32 v218, v218, v16
  v_mfma_f32_32x32x16_bf16 v[50:65], a[164:167], a[96:99], v[50:65]
  s_waitcnt lgkmcnt(6)
  ds_read_b64_tr_b16 a[188:189], v135 offset:40960
  ds_read_b64_tr_b16 a[190:191], v135 offset:41984
  v_mul_f32 v219, v219, v17
  v_exp_f32 v216, v216
  v_mfma_f32_32x32x16_bf16 v[34:49], a[168:171], a[100:103], v[34:49]
  ds_read_b64_tr_b16 a[160:161], v132 offset:32768
  ds_read_b64_tr_b16 a[162:163], v132 offset:33792
  v_exp_f32 v217, v217
  v_exp_f32 v218, v218
  v_mfma_f32_32x32x16_bf16 v[50:65], a[172:175], a[100:103], v[50:65]
  s_waitcnt lgkmcnt(6)
  ds_read_b64_tr_b16 a[164:165], v133 offset:32768
  ds_read_b64_tr_b16 a[166:167], v133 offset:33792
  v_exp_f32 v219, v219
  v_fma_f32 v216, v216, v202, v202
  v_fma_f32 v217, v217, v202, v202
  v_mfma_f32_32x32x16_bf16 v[34:49], a[176:179], a[104:107], v[34:49]
  ds_read_b64_tr_b16 a[168:169], v136 offset:32768
  ds_read_b64_tr_b16 a[170:171], v136 offset:33792
  buffer_load_dwordx4 v164, s[32:35], s54 offen offset:2048 lds
  v_fma_f32 v218, v218, v202, v202
  v_fma_f32 v219, v219, v202, v202
  v_mfma_f32_16x16x32_bf16 v[174:177], v[166:169], a[176:179], v[174:177]
  v_rcp_f32 v216, v216
  v_mfma_f32_32x32x16_bf16 v[50:65], a[180:183], a[104:107], v[50:65]
  s_waitcnt lgkmcnt(6)
  ds_read_b64_tr_b16 a[172:173], v137 offset:32768
  ds_read_b64_tr_b16 a[174:175], v137 offset:33792
  v_rcp_f32 v217, v217
  v_rcp_f32 v218, v218
  v_mfma_f32_32x32x16_bf16 v[34:49], a[184:187], a[108:111], v[34:49]
  ds_read_b64_tr_b16 a[176:177], v132 offset:40960
  ds_read_b64_tr_b16 a[178:179], v132 offset:41984
  v_rcp_f32 v219, v219
  v_mul_f32 v14, v14, v216
  v_mul_f32 v15, v15, v217
  v_mul_f32 v16, v16, v218
  v_mfma_f32_32x32x16_bf16 v[50:65], a[188:191], a[108:111], v[50:65]
  s_waitcnt lgkmcnt(6)
  ds_read_b64_tr_b16 a[180:181], v133 offset:40960
  ds_read_b64_tr_b16 a[182:183], v133 offset:41984
  v_mul_f32 v17, v17, v219
  v_add_f32 v204, v204, v14
  v_fmac_f32 v205, v14, v14
  v_add_f32 v204, v204, v15
  v_mfma_f32_32x32x16_bf16 v[34:49], a[160:163], a[112:115], v[34:49]
  ds_read_b64_tr_b16 a[184:185], v136 offset:40960
  ds_read_b64_tr_b16 a[186:187], v136 offset:41984
  buffer_load_dwordx4 v165, s[32:35], s54 offen offset:3072 lds
  v_fmac_f32 v205, v15, v15
  v_add_f32 v204, v204, v16
  v_fmac_f32 v205, v16, v16
  v_mfma_f32_16x16x32_bf16 v[174:177], v[166:169], a[160:163], v[174:177]
  v_add_f32 v204, v204, v17
  v_fmac_f32 v205, v17, v17
  v_mfma_f32_32x32x16_bf16 v[50:65], a[164:167], a[112:115], v[50:65]
  s_waitcnt lgkmcnt(6)
  ds_read_b64_tr_b16 a[188:189], v137 offset:40960
  ds_read_b64_tr_b16 a[190:191], v137 offset:41984
  v_mul_f32 v216, v18, v18
  v_mul_f32 v217, v19, v19
  v_mul_f32 v218, v20, v20
  v_mul_f32 v219, v21, v21
  v_mfma_f32_32x32x16_bf16 v[34:49], a[168:171], a[116:119], v[34:49]
  s_waitcnt vmcnt(12)
  s_barrier
  ds_read_b64_tr_b16 a[160:161], v138 offset:0
  ds_read_b64_tr_b16 a[162:163], v138 offset:1024
  v_fma_f32 v216, v216, v201, v200
  v_fma_f32 v217, v217, v201, v200
  v_fma_f32 v218, v218, v201, v200
  v_mfma_f32_32x32x16_bf16 v[50:65], a[172:175], a[116:119], v[50:65]
  s_waitcnt lgkmcnt(6)
  ds_read_b64_tr_b16 a[164:165], v139 offset:0
  ds_read_b64_tr_b16 a[166:167], v139 offset:1024
  v_fma_f32 v219, v219, v201, v200
  v_mul_f32 v216, v216, v18
  v_mul_f32 v217, v217, v19
  v_mul_f32 v218, v218, v20
  v_mfma_f32_32x32x16_bf16 v[34:49], a[176:179], a[120:123], v[34:49]
  ds_read_b64_tr_b16 a[168:169], v142 offset:0
  ds_read_b64_tr_b16 a[170:171], v142 offset:1024
  s_add_u32 m0, s56, 16384
  s_mul_i32 s54, s63, 491520
  buffer_load_dwordx4 v162, s[32:35], s54 offen offset:0 lds
  v_mul_f32 v219, v219, v21
  v_mfma_f32_16x16x32_bf16 v[174:177], v[166:169], a[176:179], v[174:177]
  v_exp_f32 v216, v216
  v_mfma_f32_32x32x16_bf16 v[50:65], a[180:183], a[120:123], v[50:65]
  s_waitcnt lgkmcnt(6)
  ds_read_b64_tr_b16 a[172:173], v143 offset:0
  ds_read_b64_tr_b16 a[174:175], v143 offset:1024
  v_exp_f32 v217, v217
  v_exp_f32 v218, v218
  v_mfma_f32_32x32x16_bf16 v[34:49], a[184:187], a[124:127], v[34:49]
  ds_read_b64_tr_b16 a[176:177], v138 offset:8192
  ds_read_b64_tr_b16 a[178:179], v138 offset:9216
  v_exp_f32 v219, v219
  v_fma_f32 v216, v216, v202, v202
  v_fma_f32 v217, v217, v202, v202
  v_fma_f32 v218, v218, v202, v202
  v_mfma_f32_32x32x16_bf16 v[50:65], a[188:191], a[124:127], v[50:65]
  s_waitcnt lgkmcnt(6)
  ds_read_b64_tr_b16 a[180:181], v139 offset:8192
  ds_read_b64_tr_b16 a[182:183], v139 offset:9216
  v_fma_f32 v219, v219, v202, v202
  v_rcp_f32 v216, v216
  v_mfma_f32_32x32x16_bf16 v[34:49], a[160:163], a[128:131], v[34:49]
  ds_read_b64_tr_b16 a[184:185], v142 offset:8192
  ds_read_b64_tr_b16 a[186:187], v142 offset:9216
  buffer_load_dwordx4 v163, s[32:35], s54 offen offset:1024 lds
  v_rcp_f32 v217, v217
  v_mfma_f32_16x16x32_bf16 v[174:177], v[166:169], a[160:163], v[174:177]
  v_rcp_f32 v218, v218
  v_mfma_f32_32x32x16_bf16 v[50:65], a[164:167], a[128:131], v[50:65]
  s_waitcnt lgkmcnt(6)
  ds_read_b64_tr_b16 a[188:189], v143 offset:8192
  ds_read_b64_tr_b16 a[190:191], v143 offset:9216
  v_rcp_f32 v219, v219
  v_mul_f32 v18, v18, v216
  v_mul_f32 v19, v19, v217
  v_mfma_f32_32x32x16_bf16 v[34:49], a[168:171], a[132:135], v[34:49]
  ds_read_b64_tr_b16 a[160:161], v140 offset:0
  ds_read_b64_tr_b16 a[162:163], v140 offset:1024
  v_mul_f32 v20, v20, v218
  v_mul_f32 v21, v21, v219
  v_add_f32 v204, v204, v18
  v_fmac_f32 v205, v18, v18
  v_add_f32 v204, v204, v19
  v_mfma_f32_32x32x16_bf16 v[50:65], a[172:175], a[132:135], v[50:65]
  s_waitcnt lgkmcnt(6)
  ds_read_b64_tr_b16 a[164:165], v141 offset:0
  ds_read_b64_tr_b16 a[166:167], v141 offset:1024
  v_fmac_f32 v205, v19, v19
  v_add_f32 v204, v204, v20
  v_fmac_f32 v205, v20, v20
  v_add_f32 v204, v204, v21
  v_mfma_f32_32x32x16_bf16 v[34:49], a[176:179], a[136:139], v[34:49]
  ds_read_b64_tr_b16 a[168:169], v144 offset:0
  ds_read_b64_tr_b16 a[170:171], v144 offset:1024
  buffer_load_dwordx4 v164, s[32:35], s54 offen offset:2048 lds
  v_fmac_f32 v205, v21, v21
  v_mul_f32 v216, v22, v22
  v_mul_f32 v217, v23, v23
  v_mfma_f32_16x16x32_bf16 v[174:177], v[166:169], a[176:179], v[174:177]
  v_mul_f32 v218, v24, v24
  v_mul_f32 v219, v25, v25
  v_mfma_f32_32x32x16_bf16 v[50:65], a[180:183], a[136:139], v[50:65]
  s_waitcnt lgkmcnt(6)
  ds_read_b64_tr_b16 a[172:173], v145 offset:0
  ds_read_b64_tr_b16 a[174:175], v145 offset:1024
  v_fma_f32 v216, v216, v201, v200
  v_fma_f32 v217, v217, v201, v200
  v_fma_f32 v218, v218, v201, v200
  v_fma_f32 v219, v219, v201, v200
  v_mfma_f32_32x32x16_bf16 v[34:49], a[184:187], a[140:143], v[34:49]
  ds_read_b64_tr_b16 a[176:177], v140 offset:8192
  ds_read_b64_tr_b16 a[178:179], v140 offset:9216
  v_mul_f32 v216, v216, v22
  v_mul_f32 v217, v217, v23
  v_mul_f32 v218, v218, v24
  v_mul_f32 v219, v219, v25
  v_mfma_f32_32x32x16_bf16 v[50:65], a[188:191], a[140:143], v[50:65]
  s_waitcnt lgkmcnt(6)
  ds_read_b64_tr_b16 a[180:181], v141 offset:8192
  ds_read_b64_tr_b16 a[182:183], v141 offset:9216
  v_exp_f32 v216, v216
  v_exp_f32 v217, v217
  v_mfma_f32_32x32x16_bf16 v[34:49], a[160:163], a[144:147], v[34:49]
  ds_read_b64_tr_b16 a[184:185], v144 offset:8192
  ds_read_b64_tr_b16 a[186:187], v144 offset:9216
  buffer_load_dwordx4 v165, s[32:35], s54 offen offset:3072 lds
  v_exp_f32 v218, v218
  v_mfma_f32_16x16x32_bf16 v[174:177], v[166:169], a[160:163], v[174:177]
  v_exp_f32 v219, v219
  v_mfma_f32_32x32x16_bf16 v[50:65], a[164:167], a[144:147], v[50:65]
  s_waitcnt lgkmcnt(6)
  ds_read_b64_tr_b16 a[188:189], v145 offset:8192
  ds_read_b64_tr_b16 a[190:191], v145 offset:9216
  v_fma_f32 v216, v216, v202, v202
  v_fma_f32 v217, v217, v202, v202
  v_fma_f32 v218, v218, v202, v202
  v_fma_f32 v219, v219, v202, v202
  v_mfma_f32_32x32x16_bf16 v[34:49], a[168:171], a[148:151], v[34:49]
  s_waitcnt vmcnt(12)
  s_barrier
  ds_read_b64_tr_b16 a[160:161], v138 offset:16384
  ds_read_b64_tr_b16 a[162:163], v138 offset:17408
  v_rcp_f32 v216, v216
  v_mfma_f32_32x32x16_bf16 v[50:65], a[172:175], a[148:151], v[50:65]
  s_waitcnt lgkmcnt(6)
  ds_read_b64_tr_b16 a[164:165], v139 offset:16384
  ds_read_b64_tr_b16 a[166:167], v139 offset:17408
  v_rcp_f32 v217, v217
  v_rcp_f32 v218, v218
  v_mfma_f32_32x32x16_bf16 v[34:49], a[176:179], a[152:155], v[34:49]
  ds_read_b64_tr_b16 a[168:169], v142 offset:16384
  ds_read_b64_tr_b16 a[170:171], v142 offset:17408
  s_add_u32 m0, s56, 32768
  s_mul_i32 s54, s64, 491520
  buffer_load_dwordx4 v162, s[32:35], s54 offen offset:0 lds
  v_mfma_f32_16x16x32_bf16 v[174:177], v[166:169], a[176:179], v[174:177]
  v_rcp_f32 v219, v219
  v_mfma_f32_32x32x16_bf16 v[50:65], a[180:183], a[152:155], v[50:65]
  s_waitcnt lgkmcnt(6)
  ds_read_b64_tr_b16 a[172:173], v143 offset:16384
  ds_read_b64_tr_b16 a[174:175], v143 offset:17408
  v_mul_f32 v22, v22, v216
  v_mul_f32 v23, v23, v217
  v_mul_f32 v24, v24, v218
  v_mul_f32 v25, v25, v219
  v_mfma_f32_32x32x16_bf16 v[34:49], a[184:187], a[156:159], v[34:49]
  ds_read_b64_tr_b16 a[176:177], v138 offset:24576
  ds_read_b64_tr_b16 a[178:179], v138 offset:25600
  v_add_f32 v204, v204, v22
  v_fmac_f32 v205, v22, v22
  v_add_f32 v204, v204, v23
  v_fmac_f32 v205, v23, v23
  v_add_f32 v204, v204, v24
  v_mfma_f32_32x32x16_bf16 v[50:65], a[188:191], a[156:159], v[50:65]
  s_waitcnt lgkmcnt(6)
  ds_read_b64_tr_b16 a[180:181], v139 offset:24576
  ds_read_b64_tr_b16 a[182:183], v139 offset:25600
  v_fmac_f32 v205, v24, v24
  v_add_f32 v204, v204, v25
  v_fmac_f32 v205, v25, v25
  v_mul_f32 v216, v26, v26
  v_mfma_f32_32x32x16_bf16 v[66:81], a[160:163], a[0:3], 0
  ds_read_b64_tr_b16 a[184:185], v142 offset:24576
  ds_read_b64_tr_b16 a[186:187], v142 offset:25600
  buffer_load_dwordx4 v163, s[32:35], s54 offen offset:1024 lds
  v_mul_f32 v217, v27, v27
  v_mul_f32 v218, v28, v28
  v_mul_f32 v219, v29, v29
  v_mfma_f32_16x16x32_bf16 v[170:173], v[166:169], a[160:163], 0
  v_fma_f32 v216, v216, v201, v200
  v_fma_f32 v217, v217, v201, v200
  v_mfma_f32_32x32x16_bf16 v[82:97], a[164:167], a[0:3], 0
  s_waitcnt lgkmcnt(6)
  ds_read_b64_tr_b16 a[188:189], v143 offset:24576
  ds_read_b64_tr_b16 a[190:191], v143 offset:25600
  v_cvt_pk_bf16_f32 v175, v174, v174
  v_and_b32 v176, 0xffff0000, v175
  v_sub_f32 v176, v174, v176
  v_cvt_pk_bf16_f32 v174, v174, v176
  v_and_b32 v175, 0xffff, v175
  v_mfma_f32_32x32x16_bf16 v[66:81], a[168:171], a[4:7], v[66:81]
  ds_write_b64 v207, v[174:175] offset:256
  ds_read_b64_tr_b16 a[160:161], v140 offset:16384
  ds_read_b64_tr_b16 a[162:163], v140 offset:17408
  v_fma_f32 v218, v218, v201, v200
  v_fma_f32 v219, v219, v201, v200
  v_mul_f32 v216, v216, v26
  v_mfma_f32_32x32x16_bf16 v[82:97], a[172:175], a[4:7], v[82:97]
  s_waitcnt lgkmcnt(7)
  ds_read_b64_tr_b16 a[164:165], v141 offset:16384
  ds_read_b64_tr_b16 a[166:167], v141 offset:17408
  v_mul_f32 v217, v217, v27
  v_mul_f32 v218, v218, v28
  v_mul_f32 v219, v219, v29
  v_mfma_f32_32x32x16_bf16 v[66:81], a[176:179], a[8:11], v[66:81]
  ds_read_b64_tr_b16 a[168:169], v144 offset:16384
  ds_read_b64_tr_b16 a[170:171], v144 offset:17408
  buffer_load_dwordx4 v164, s[32:35], s54 offen offset:2048 lds
  v_exp_f32 v216, v216
  v_mfma_f32_16x16x32_bf16 v[170:173], v[166:169], a[176:179], v[170:173]
  v_exp_f32 v217, v217
  v_mfma_f32_32x32x16_bf16 v[82:97], a[180:183], a[8:11], v[82:97]
  s_waitcnt lgkmcnt(6)
  s_barrier
  ds_read_b64 v[192:193], v196 offset:256
  ds_read_b64 v[194:195], v197 offset:256
  ds_read_b64_tr_b16 a[172:173], v145 offset:16384
  ds_read_b64_tr_b16 a[174:175], v145 offset:17408
  v_mfma_f32_32x32x16_bf16 v[66:81], a[184:187], a[12:15], v[66:81]
  ds_read_b64_tr_b16 a[176:177], v140 offset:24576
  ds_read_b64_tr_b16 a[178:179], v140 offset:25600
  v_exp_f32 v218, v218
  v_exp_f32 v219, v219
  v_fma_f32 v216, v216, v202, v202
  v_mfma_f32_32x32x16_bf16 v[82:97], a[188:191], a[12:15], v[82:97]
  s_waitcnt lgkmcnt(8)
  ds_read_b64_tr_b16 a[180:181], v141 offset:24576
  ds_read_b64_tr_b16 a[182:183], v141 offset:25600
  v_fma_f32 v217, v217, v202, v202
  v_fma_f32 v218, v218, v202, v202
  v_fma_f32 v219, v219, v202, v202
  v_mfma_f32_32x32x16_bf16 v[66:81], a[160:163], a[16:19], v[66:81]
  s_waitcnt lgkmcnt(6)
  ds_read_b64_tr_b16 a[184:185], v144 offset:24576
  ds_read_b64_tr_b16 a[186:187], v144 offset:25600
  buffer_load_dwordx4 v165, s[32:35], s54 offen offset:3072 lds
  v_rcp_f32 v216, v216
  v_mfma_f32_16x16x32_bf16 v[170:173], v[166:169], a[160:163], v[170:173]
  v_rcp_f32 v217, v217
  s_nop 1
  v_mfma_f32_32x32x8_bf16 v[34:49], v[192:193], v[190:191], v[34:49]
  v_rcp_f32 v218, v218
  v_rcp_f32 v219, v219
  v_mul_f32 v26, v26, v216
  v_mfma_f32_32x32x16_bf16 v[82:97], a[164:167], a[16:19], v[82:97]
  s_waitcnt lgkmcnt(6)
  ds_read_b64_tr_b16 a[188:189], v145 offset:24576
  ds_read_b64_tr_b16 a[190:191], v145 offset:25600
  v_mul_f32 v27, v27, v217
  v_mul_f32 v28, v28, v218
  v_mul_f32 v29, v29, v219
  v_add_f32 v204, v204, v26
  s_nop 1
  v_mfma_f32_32x32x8_bf16 v[50:65], v[194:195], v[190:191], v[50:65]
  v_fmac_f32 v205, v26, v26
  v_add_f32 v204, v204, v27
  v_fmac_f32 v205, v27, v27
  v_add_f32 v204, v204, v28
  v_fmac_f32 v205, v28, v28
  v_mfma_f32_32x32x16_bf16 v[66:81], a[168:171], a[20:23], v[66:81]
  s_waitcnt vmcnt(12)
  s_barrier
  ds_read_b64_tr_b16 a[160:161], v138 offset:32768
  ds_read_b64_tr_b16 a[162:163], v138 offset:33792
  v_add_f32 v204, v204, v29
  v_fmac_f32 v205, v29, v29
  v_mul_f32 v216, v30, v30
  v_mfma_f32_32x32x16_bf16 v[82:97], a[172:175], a[20:23], v[82:97]
  s_waitcnt lgkmcnt(6)
  ds_read_b64_tr_b16 a[164:165], v139 offset:32768
  ds_read_b64_tr_b16 a[166:167], v139 offset:33792
  v_mul_f32 v217, v31, v31
  v_mul_f32 v218, v32, v32
  v_mul_f32 v219, v33, v33
  v_fma_f32 v216, v216, v201, v200
  v_mfma_f32_32x32x16_bf16 v[66:81], a[176:179], a[24:27], v[66:81]
  ds_read_b64_tr_b16 a[168:169], v142 offset:32768
  ds_read_b64_tr_b16 a[170:171], v142 offset:33792
  s_add_u32 m0, s56, 49152
  s_mul_i32 s54, s60, 491520
  s_add_u32 s32, s32, 1920
  s_addc_u32 s33, s33, 0
  s_sub_u32 s34, s34, 1920
  buffer_load_dwordx4 v162, s[32:35], s54 offen offset:0 lds
  v_mfma_f32_16x16x32_bf16 v[170:173], v[166:169], a[176:179], v[170:173]
  v_mfma_f32_32x32x16_bf16 v[82:97], a[180:183], a[24:27], v[82:97]
  s_waitcnt lgkmcnt(6)
  ds_read_b64_tr_b16 a[172:173], v143 offset:32768
  ds_read_b64_tr_b16 a[174:175], v143 offset:33792
  v_fma_f32 v217, v217, v201, v200
  v_fma_f32 v218, v218, v201, v200
  v_fma_f32 v219, v219, v201, v200
  v_mul_f32 v216, v216, v30
  v_mfma_f32_32x32x16_bf16 v[66:81], a[184:187], a[28:31], v[66:81]
  ds_read_b64_tr_b16 a[176:177], v138 offset:40960
  ds_read_b64_tr_b16 a[178:179], v138 offset:41984
  v_mul_f32 v217, v217, v31
  v_mul_f32 v218, v218, v32
  v_mul_f32 v219, v219, v33
  v_exp_f32 v216, v216
  v_mfma_f32_32x32x16_bf16 v[82:97], a[188:191], a[28:31], v[82:97]
  s_waitcnt lgkmcnt(6)
  ds_read_b64_tr_b16 a[180:181], v139 offset:40960
  ds_read_b64_tr_b16 a[182:183], v139 offset:41984
  v_exp_f32 v217, v217
  v_exp_f32 v218, v218
  v_mfma_f32_32x32x16_bf16 v[66:81], a[160:163], a[32:35], v[66:81]
  ds_read_b64_tr_b16 a[184:185], v142 offset:40960
  ds_read_b64_tr_b16 a[186:187], v142 offset:41984
  buffer_load_dwordx4 v163, s[32:35], s54 offen offset:1024 lds
  v_exp_f32 v219, v219
  v_fma_f32 v216, v216, v202, v202
  v_mfma_f32_16x16x32_bf16 v[170:173], v[166:169], a[160:163], v[170:173]
  v_fma_f32 v217, v217, v202, v202
  v_fma_f32 v218, v218, v202, v202
  v_mfma_f32_32x32x16_bf16 v[82:97], a[164:167], a[32:35], v[82:97]
  s_waitcnt lgkmcnt(6)
  ds_read_b64_tr_b16 a[188:189], v143 offset:40960
  ds_read_b64_tr_b16 a[190:191], v143 offset:41984
  v_fma_f32 v219, v219, v202, v202
  v_rcp_f32 v216, v216
  v_mfma_f32_32x32x16_bf16 v[66:81], a[168:171], a[36:39], v[66:81]
  ds_read_b64_tr_b16 a[160:161], v140 offset:32768
  ds_read_b64_tr_b16 a[162:163], v140 offset:33792
  v_rcp_f32 v217, v217
  v_rcp_f32 v218, v218
  v_mfma_f32_32x32x16_bf16 v[82:97], a[172:175], a[36:39], v[82:97]
  s_waitcnt lgkmcnt(6)
  ds_read_b64_tr_b16 a[164:165], v141 offset:32768
  ds_read_b64_tr_b16 a[166:167], v141 offset:33792
  v_rcp_f32 v219, v219
  v_mul_f32 v30, v30, v216
  v_mul_f32 v31, v31, v217
  v_mfma_f32_32x32x16_bf16 v[66:81], a[176:179], a[40:43], v[66:81]
  ds_read_b64_tr_b16 a[168:169], v144 offset:32768
  ds_read_b64_tr_b16 a[170:171], v144 offset:33792
  buffer_load_dwordx4 v164, s[32:35], s54 offen offset:2048 lds
  v_mul_f32 v32, v32, v218
  v_mul_f32 v33, v33, v219
  v_add_f32 v204, v204, v30
  v_mfma_f32_16x16x32_bf16 v[170:173], v[166:169], a[176:179], v[170:173]
  v_fmac_f32 v205, v30, v30
  v_add_f32 v204, v204, v31
  v_mfma_f32_32x32x16_bf16 v[82:97], a[180:183], a[40:43], v[82:97]
  s_waitcnt lgkmcnt(6)
  ds_read_b64_tr_b16 a[172:173], v145 offset:32768
  ds_read_b64_tr_b16 a[174:175], v145 offset:33792
  v_fmac_f32 v205, v31, v31
  v_add_f32 v204, v204, v32
  v_fmac_f32 v205, v32, v32
  v_add_f32 v204, v204, v33
  v_mfma_f32_32x32x16_bf16 v[66:81], a[184:187], a[44:47], v[66:81]
  ds_read_b64_tr_b16 a[176:177], v140 offset:40960
  ds_read_b64_tr_b16 a[178:179], v140 offset:41984
  v_fmac_f32 v205, v33, v33
k1_c0:
  v_cmp_ne_u32 vcc, 15, v226
  s_nop 1
  s_cbranch_vccz k1_c1
  s_add_u32 s59, s59, 0x4000
  s_cbranch_scc1 k1_c1
  buffer_load_dword v226, v210, s[40:43], 0 offen sc1
  s_waitcnt vmcnt(0)
  s_branch k1_c0
k1_c1:
  v_permlane32_swap_b32 v204, v205
  v_mfma_f32_32x32x16_bf16 v[82:97], a[188:191], a[44:47], v[82:97]
  s_waitcnt lgkmcnt(6)
  ds_read_b64_tr_b16 a[180:181], v141 offset:40960
  ds_read_b64_tr_b16 a[182:183], v141 offset:41984
  s_nop 1
  v_add_f32 v204, v204, v205
  v_min_u32 v204, -2, v204
  buffer_store_dword v204, v206, s[36:39], s58 offen sc0 sc1
  v_mfma_f32_32x32x16_bf16 v[66:81], a[160:163], a[48:51], v[66:81]
  ds_read_b64_tr_b16 a[184:185], v144 offset:40960
  ds_read_b64_tr_b16 a[186:187], v144 offset:41984
  buffer_load_dwordx4 v165, s[32:35], s54 offen offset:3072 lds
  v_mul_f32 v216, v34, v34
  v_mul_f32 v217, v35, v35
  v_mul_f32 v218, v36, v36
  v_mfma_f32_16x16x32_bf16 v[170:173], v[166:169], a[160:163], v[170:173]
  v_mul_f32 v219, v37, v37
  v_fma_f32 v216, v216, v201, v200
  v_mfma_f32_32x32x16_bf16 v[82:97], a[164:167], a[48:51], v[82:97]
  s_waitcnt lgkmcnt(6)
  ds_read_b64_tr_b16 a[188:189], v145 offset:40960
  ds_read_b64_tr_b16 a[190:191], v145 offset:41984
  v_fma_f32 v217, v217, v201, v200
  v_fma_f32 v218, v218, v201, v200
  v_fma_f32 v219, v219, v201, v200
  v_mul_f32 v216, v216, v34
  v_mfma_f32_32x32x16_bf16 v[66:81], a[168:171], a[52:55], v[66:81]
  s_waitcnt vmcnt(13)
  s_barrier
  ds_read_b64_tr_b16 a[160:161], v130 offset:0
  ds_read_b64_tr_b16 a[162:163], v130 offset:1024
  v_mul_f32 v217, v217, v35
  v_mul_f32 v218, v218, v36
  v_mul_f32 v219, v219, v37
  v_mfma_f32_32x32x16_bf16 v[82:97], a[172:175], a[52:55], v[82:97]
  s_waitcnt lgkmcnt(6)
  ds_read_b64_tr_b16 a[164:165], v131 offset:0
  ds_read_b64_tr_b16 a[166:167], v131 offset:1024
  v_exp_f32 v216, v216
  v_exp_f32 v217, v217
  v_mfma_f32_32x32x16_bf16 v[66:81], a[176:179], a[56:59], v[66:81]
  ds_read_b64_tr_b16 a[168:169], v134 offset:0
  ds_read_b64_tr_b16 a[170:171], v134 offset:1024
  s_add_u32 m0, s56, 65536
  s_mul_i32 s54, s61, 491520
  buffer_load_dwordx4 v162, s[32:35], s54 offen offset:0 lds
  v_mfma_f32_16x16x32_bf16 v[170:173], v[166:169], a[176:179], v[170:173]
  v_exp_f32 v218, v218
  v_mfma_f32_32x32x16_bf16 v[82:97], a[180:183], a[56:59], v[82:97]
  s_waitcnt lgkmcnt(6)
  ds_read_b64_tr_b16 a[172:173], v135 offset:0
  ds_read_b64_tr_b16 a[174:175], v135 offset:1024
  v_exp_f32 v219, v219
  v_fma_f32 v216, v216, v202, v202
  v_fma_f32 v217, v217, v202, v202
  v_mfma_f32_32x32x16_bf16 v[66:81], a[184:187], a[60:63], v[66:81]
  ds_read_b64_tr_b16 a[176:177], v130 offset:8192
  ds_read_b64_tr_b16 a[178:179], v130 offset:9216
  v_fma_f32 v218, v218, v202, v202
  v_fma_f32 v219, v219, v202, v202
  v_rcp_f32 v216, v216
  v_mfma_f32_32x32x16_bf16 v[82:97], a[188:191], a[60:63], v[82:97]
  s_waitcnt lgkmcnt(6)
  ds_read_b64_tr_b16 a[180:181], v131 offset:8192
  ds_read_b64_tr_b16 a[182:183], v131 offset:9216
  v_rcp_f32 v217, v217
  v_rcp_f32 v218, v218
  v_mfma_f32_32x32x16_bf16 v[66:81], a[160:163], a[64:67], v[66:81]
  ds_read_b64_tr_b16 a[184:185], v134 offset:8192
  ds_read_b64_tr_b16 a[186:187], v134 offset:9216
  buffer_load_dwordx4 v163, s[32:35], s54 offen offset:1024 lds
  v_rcp_f32 v219, v219
  v_mul_f32 v34, v34, v216
  v_mfma_f32_16x16x32_bf16 v[170:173], v[166:169], a[160:163], v[170:173]
  v_mul_f32 v35, v35, v217
  v_mul_f32 v36, v36, v218
  v_mfma_f32_32x32x16_bf16 v[82:97], a[164:167], a[64:67], v[82:97]
  s_waitcnt lgkmcnt(6)
  ds_read_b64_tr_b16 a[188:189], v135 offset:8192
  ds_read_b64_tr_b16 a[190:191], v135 offset:9216
  v_mul_f32 v37, v37, v219
  v_cvt_pk_bf16_f32 v34, v34, v35
  v_cvt_pk_bf16_f32 v35, v36, v37
  v_mul_f32 v216, v38, v38
  v_mfma_f32_32x32x16_bf16 v[66:81], a[168:171], a[68:71], v[66:81]
  ds_read_b64_tr_b16 a[160:161], v132 offset:0
  ds_read_b64_tr_b16 a[162:163], v132 offset:1024
  v_mul_f32 v217, v39, v39
  v_mul_f32 v218, v40, v40
  v_mul_f32 v219, v41, v41
  v_fma_f32 v216, v216, v201, v200
  v_fma_f32 v217, v217, v201, v200
  v_mfma_f32_32x32x16_bf16 v[82:97], a[172:175], a[68:71], v[82:97]
  s_waitcnt lgkmcnt(6)
  ds_read_b64_tr_b16 a[164:165], v133 offset:0
  ds_read_b64_tr_b16 a[166:167], v133 offset:1024
  v_fma_f32 v218, v218, v201, v200
  v_fma_f32 v219, v219, v201, v200
  v_mul_f32 v216, v216, v38
  v_mul_f32 v217, v217, v39
  v_mfma_f32_32x32x16_bf16 v[66:81], a[176:179], a[72:75], v[66:81]
  ds_read_b64_tr_b16 a[168:169], v136 offset:0
  ds_read_b64_tr_b16 a[170:171], v136 offset:1024
  buffer_load_dwordx4 v164, s[32:35], s54 offen offset:2048 lds
  v_mul_f32 v218, v218, v40
  v_mul_f32 v219, v219, v41
  v_mfma_f32_16x16x32_bf16 v[170:173], v[166:169], a[176:179], v[170:173]
  v_exp_f32 v216, v216
  v_mfma_f32_32x32x16_bf16 v[82:97], a[180:183], a[72:75], v[82:97]
  s_waitcnt lgkmcnt(6)
  ds_read_b64_tr_b16 a[172:173], v137 offset:0
  ds_read_b64_tr_b16 a[174:175], v137 offset:1024
  v_exp_f32 v217, v217
  v_exp_f32 v218, v218
  v_mfma_f32_32x32x16_bf16 v[66:81], a[184:187], a[76:79], v[66:81]
  ds_read_b64_tr_b16 a[176:177], v132 offset:8192
  ds_read_b64_tr_b16 a[178:179], v132 offset:9216
  v_exp_f32 v219, v219
  v_fma_f32 v216, v216, v202, v202
  v_fma_f32 v217, v217, v202, v202
  v_fma_f32 v218, v218, v202, v202
  v_mfma_f32_32x32x16_bf16 v[82:97], a[188:191], a[76:79], v[82:97]
  s_waitcnt lgkmcnt(6)
  ds_read_b64_tr_b16 a[180:181], v133 offset:8192
  ds_read_b64_tr_b16 a[182:183], v133 offset:9216
  v_fma_f32 v219, v219, v202, v202
  v_rcp_f32 v216, v216
  v_mfma_f32_32x32x16_bf16 v[66:81], a[160:163], a[80:83], v[66:81]
  ds_read_b64_tr_b16 a[184:185], v136 offset:8192
  ds_read_b64_tr_b16 a[186:187], v136 offset:9216
  buffer_load_dwordx4 v165, s[32:35], s54 offen offset:3072 lds
  v_rcp_f32 v217, v217
  v_mfma_f32_16x16x32_bf16 v[170:173], v[166:169], a[160:163], v[170:173]
  v_rcp_f32 v218, v218
  v_mfma_f32_32x32x16_bf16 v[82:97], a[164:167], a[80:83], v[82:97]
  s_waitcnt lgkmcnt(6)
  ds_read_b64_tr_b16 a[188:189], v137 offset:8192
  ds_read_b64_tr_b16 a[190:191], v137 offset:9216
  v_rcp_f32 v219, v219
  v_mul_f32 v38, v38, v216
  v_mul_f32 v39, v39, v217
  v_mfma_f32_32x32x16_bf16 v[66:81], a[168:171], a[84:87], v[66:81]
  s_waitcnt vmcnt(13)
  s_barrier
  ds_read_b64_tr_b16 a[160:161], v130 offset:16384
  ds_read_b64_tr_b16 a[162:163], v130 offset:17408
  v_mul_f32 v40, v40, v218
  v_mul_f32 v41, v41, v219
  v_cvt_pk_bf16_f32 v36, v38, v39
  v_mfma_f32_32x32x16_bf16 v[82:97], a[172:175], a[84:87], v[82:97]
  s_waitcnt lgkmcnt(6)
  ds_read_b64_tr_b16 a[164:165], v131 offset:16384
  ds_read_b64_tr_b16 a[166:167], v131 offset:17408
  v_cvt_pk_bf16_f32 v37, v40, v41
  v_mfma_f32_32x32x16_bf16 v[66:81], a[176:179], a[88:91], v[66:81]
  ds_read_b64_tr_b16 a[168:169], v134 offset:16384
  ds_read_b64_tr_b16 a[170:171], v134 offset:17408
  s_add_u32 m0, s56, 81920
  s_mul_i32 s54, s62, 491520
  buffer_load_dwordx4 v162, s[32:35], s54 offen offset:0 lds
  v_mfma_f32_16x16x32_bf16 v[170:173], v[166:169], a[176:179], v[170:173]
  v_mfma_f32_32x32x16_bf16 v[82:97], a[180:183], a[88:91], v[82:97]
  s_waitcnt lgkmcnt(6)
  ds_read_b64_tr_b16 a[172:173], v135 offset:16384
  ds_read_b64_tr_b16 a[174:175], v135 offset:17408
  buffer_store_dwordx4 v[34:37], v152, s[36:39], 0 offen offset:0 sc0 sc1
  v_mfma_f32_32x32x16_bf16 v[66:81], a[184:187], a[92:95], v[66:81]
  ds_read_b64_tr_b16 a[176:177], v130 offset:24576
  ds_read_b64_tr_b16 a[178:179], v130 offset:25600
  v_mul_f32 v216, v42, v42
  v_mul_f32 v217, v43, v43
  v_mul_f32 v218, v44, v44
  v_mfma_f32_32x32x16_bf16 v[82:97], a[188:191], a[92:95], v[82:97]
  s_waitcnt lgkmcnt(6)
  ds_read_b64_tr_b16 a[180:181], v131 offset:24576
  ds_read_b64_tr_b16 a[182:183], v131 offset:25600
  v_mul_f32 v219, v45, v45
  v_fma_f32 v216, v216, v201, v200
  v_fma_f32 v217, v217, v201, v200
  v_fma_f32 v218, v218, v201, v200
  v_mfma_f32_32x32x16_bf16 v[66:81], a[160:163], a[96:99], v[66:81]
  ds_read_b64_tr_b16 a[184:185], v134 offset:24576
  ds_read_b64_tr_b16 a[186:187], v134 offset:25600
  buffer_load_dwordx4 v163, s[32:35], s54 offen offset:1024 lds
  v_fma_f32 v219, v219, v201, v200
  v_mul_f32 v216, v216, v42
  v_mul_f32 v217, v217, v43
  v_mfma_f32_16x16x32_bf16 v[170:173], v[166:169], a[160:163], v[170:173]
  v_mul_f32 v218, v218, v44
  v_mul_f32 v219, v219, v45
  v_mfma_f32_32x32x16_bf16 v[82:97], a[164:167], a[96:99], v[82:97]
  s_waitcnt lgkmcnt(6)
  ds_read_b64_tr_b16 a[188:189], v135 offset:24576
  ds_read_b64_tr_b16 a[190:191], v135 offset:25600
  v_exp_f32 v216, v216
  v_exp_f32 v217, v217
  v_mfma_f32_32x32x16_bf16 v[66:81], a[168:171], a[100:103], v[66:81]
  ds_read_b64_tr_b16 a[160:161], v132 offset:16384
  ds_read_b64_tr_b16 a[162:163], v132 offset:17408
  v_exp_f32 v218, v218
  v_exp_f32 v219, v219
  v_fma_f32 v216, v216, v202, v202
  v_mfma_f32_32x32x16_bf16 v[82:97], a[172:175], a[100:103], v[82:97]
  s_waitcnt lgkmcnt(6)
  ds_read_b64_tr_b16 a[164:165], v133 offset:16384
  ds_read_b64_tr_b16 a[166:167], v133 offset:17408
  v_fma_f32 v217, v217, v202, v202
  v_fma_f32 v218, v218, v202, v202
  v_fma_f32 v219, v219, v202, v202
  v_mfma_f32_32x32x16_bf16 v[66:81], a[176:179], a[104:107], v[66:81]
  ds_read_b64_tr_b16 a[168:169], v136 offset:16384
  ds_read_b64_tr_b16 a[170:171], v136 offset:17408
  buffer_load_dwordx4 v164, s[32:35], s54 offen offset:2048 lds
  v_rcp_f32 v216, v216
  v_mfma_f32_16x16x32_bf16 v[170:173], v[166:169], a[176:179], v[170:173]
  v_rcp_f32 v217, v217
  v_mfma_f32_32x32x16_bf16 v[82:97], a[180:183], a[104:107], v[82:97]
  s_waitcnt lgkmcnt(6)
  ds_read_b64_tr_b16 a[172:173], v137 offset:16384
  ds_read_b64_tr_b16 a[174:175], v137 offset:17408
  v_rcp_f32 v218, v218
  v_rcp_f32 v219, v219
  v_mfma_f32_32x32x16_bf16 v[66:81], a[184:187], a[108:111], v[66:81]
  ds_read_b64_tr_b16 a[176:177], v132 offset:24576
  ds_read_b64_tr_b16 a[178:179], v132 offset:25600
  v_mul_f32 v42, v42, v216
  v_mul_f32 v43, v43, v217
  v_mul_f32 v44, v44, v218
  v_mul_f32 v45, v45, v219
  v_cvt_pk_bf16_f32 v38, v42, v43
  v_mfma_f32_32x32x16_bf16 v[82:97], a[188:191], a[108:111], v[82:97]
  s_waitcnt lgkmcnt(6)
  ds_read_b64_tr_b16 a[180:181], v133 offset:24576
  ds_read_b64_tr_b16 a[182:183], v133 offset:25600
  v_cvt_pk_bf16_f32 v39, v44, v45
  v_mul_f32 v216, v46, v46
  v_mul_f32 v217, v47, v47
  v_mul_f32 v218, v48, v48
  v_mfma_f32_32x32x16_bf16 v[66:81], a[160:163], a[112:115], v[66:81]
  ds_read_b64_tr_b16 a[184:185], v136 offset:24576
  ds_read_b64_tr_b16 a[186:187], v136 offset:25600
  buffer_load_dwordx4 v165, s[32:35], s54 offen offset:3072 lds
  v_mul_f32 v219, v49, v49
  v_fma_f32 v216, v216, v201, v200
  v_fma_f32 v217, v217, v201, v200
  v_mfma_f32_16x16x32_bf16 v[170:173], v[166:169], a[160:163], v[170:173]
  v_fma_f32 v218, v218, v201, v200
  v_fma_f32 v219, v219, v201, v200
  v_mfma_f32_32x32x16_bf16 v[82:97], a[164:167], a[112:115], v[82:97]
  s_waitcnt lgkmcnt(6)
  ds_read_b64_tr_b16 a[188:189], v137 offset:24576
  ds_read_b64_tr_b16 a[190:191], v137 offset:25600
  v_mul_f32 v216, v216, v46
  v_mul_f32 v217, v217, v47
  v_mul_f32 v218, v218, v48
  v_mul_f32 v219, v219, v49
  v_mfma_f32_32x32x16_bf16 v[66:81], a[168:171], a[116:119], v[66:81]
  s_waitcnt vmcnt(14)
  s_barrier
  ds_read_b64_tr_b16 a[160:161], v130 offset:32768
  ds_read_b64_tr_b16 a[162:163], v130 offset:33792
  v_exp_f32 v216, v216
  v_mfma_f32_32x32x16_bf16 v[82:97], a[172:175], a[116:119], v[82:97]
  s_waitcnt lgkmcnt(6)
  ds_read_b64_tr_b16 a[164:165], v131 offset:32768
  ds_read_b64_tr_b16 a[166:167], v131 offset:33792
  v_exp_f32 v217, v217
  v_exp_f32 v218, v218
  v_mfma_f32_32x32x16_bf16 v[66:81], a[176:179], a[120:123], v[66:81]
  ds_read_b64_tr_b16 a[168:169], v134 offset:32768
  ds_read_b64_tr_b16 a[170:171], v134 offset:33792
  s_add_u32 m0, s56, 0
  s_mul_i32 s54, s63, 491520
  buffer_load_dwordx4 v162, s[32:35], s54 offen offset:0 lds
  v_mfma_f32_16x16x32_bf16 v[170:173], v[166:169], a[176:179], v[170:173]
  v_exp_f32 v219, v219
  v_mfma_f32_32x32x16_bf16 v[82:97], a[180:183], a[120:123], v[82:97]
  s_waitcnt lgkmcnt(6)
  ds_read_b64_tr_b16 a[172:173], v135 offset:32768
  ds_read_b64_tr_b16 a[174:175], v135 offset:33792
  v_fma_f32 v216, v216, v202, v202
  v_fma_f32 v217, v217, v202, v202
  v_fma_f32 v218, v218, v202, v202
  v_fma_f32 v219, v219, v202, v202
  v_mfma_f32_32x32x16_bf16 v[66:81], a[184:187], a[124:127], v[66:81]
  ds_read_b64_tr_b16 a[176:177], v130 offset:40960
  ds_read_b64_tr_b16 a[178:179], v130 offset:41984
  v_rcp_f32 v216, v216
  v_rcp_f32 v217, v217
  v_mfma_f32_32x32x16_bf16 v[82:97], a[188:191], a[124:127], v[82:97]
  s_waitcnt lgkmcnt(6)
  ds_read_b64_tr_b16 a[180:181], v131 offset:40960
  ds_read_b64_tr_b16 a[182:183], v131 offset:41984
  v_rcp_f32 v218, v218
  v_rcp_f32 v219, v219
  v_mfma_f32_32x32x16_bf16 v[66:81], a[160:163], a[128:131], v[66:81]
  ds_read_b64_tr_b16 a[184:185], v134 offset:40960
  ds_read_b64_tr_b16 a[186:187], v134 offset:41984
  buffer_load_dwordx4 v163, s[32:35], s54 offen offset:1024 lds
  v_mul_f32 v46, v46, v216
  v_mul_f32 v47, v47, v217
  v_mul_f32 v48, v48, v218
  v_mfma_f32_16x16x32_bf16 v[170:173], v[166:169], a[160:163], v[170:173]
  v_mul_f32 v49, v49, v219
  v_cvt_pk_bf16_f32 v40, v46, v47
  v_mfma_f32_32x32x16_bf16 v[82:97], a[164:167], a[128:131], v[82:97]
  s_waitcnt lgkmcnt(6)
  ds_read_b64_tr_b16 a[188:189], v135 offset:40960
  ds_read_b64_tr_b16 a[190:191], v135 offset:41984
  v_cvt_pk_bf16_f32 v41, v48, v49
  v_mfma_f32_32x32x16_bf16 v[66:81], a[168:171], a[132:135], v[66:81]
  ds_read_b64_tr_b16 a[160:161], v132 offset:32768
  ds_read_b64_tr_b16 a[162:163], v132 offset:33792
  buffer_load_dword v232, v206, s[36:39], 0 offen offset:0 sc1
  v_mfma_f32_32x32x16_bf16 v[82:97], a[172:175], a[132:135], v[82:97]
  s_waitcnt lgkmcnt(6)
  ds_read_b64_tr_b16 a[164:165], v133 offset:32768
  ds_read_b64_tr_b16 a[166:167], v133 offset:33792
  buffer_store_dwordx4 v[38:41], v152, s[36:39], 0 offen offset:1024 sc0 sc1
  v_mfma_f32_32x32x16_bf16 v[66:81], a[176:179], a[136:139], v[66:81]
  ds_read_b64_tr_b16 a[168:169], v136 offset:32768
  ds_read_b64_tr_b16 a[170:171], v136 offset:33792
  buffer_load_dwordx4 v164, s[32:35], s54 offen offset:2048 lds
  buffer_load_dword v233, v206, s[36:39], 0 offen offset:256 sc1
  v_mfma_f32_16x16x32_bf16 v[170:173], v[166:169], a[176:179], v[170:173]
  v_mul_f32 v216, v50, v50
  v_mfma_f32_32x32x16_bf16 v[82:97], a[180:183], a[136:139], v[82:97]
  s_waitcnt lgkmcnt(6)
  ds_read_b64_tr_b16 a[172:173], v137 offset:32768
  ds_read_b64_tr_b16 a[174:175], v137 offset:33792
  v_mul_f32 v217, v51, v51
  v_mul_f32 v218, v52, v52
  v_mul_f32 v219, v53, v53
  v_fma_f32 v216, v216, v201, v200
  v_mfma_f32_32x32x16_bf16 v[66:81], a[184:187], a[140:143], v[66:81]
  ds_read_b64_tr_b16 a[176:177], v132 offset:40960
  ds_read_b64_tr_b16 a[178:179], v132 offset:41984
  buffer_load_dword v234, v206, s[36:39], 0 offen offset:512 sc1
  v_fma_f32 v217, v217, v201, v200
  v_fma_f32 v218, v218, v201, v200
  v_fma_f32 v219, v219, v201, v200
  v_mfma_f32_32x32x16_bf16 v[82:97], a[188:191], a[140:143], v[82:97]
  s_waitcnt lgkmcnt(6)
  ds_read_b64_tr_b16 a[180:181], v133 offset:40960
  ds_read_b64_tr_b16 a[182:183], v133 offset:41984
  v_mul_f32 v216, v216, v50
  v_mul_f32 v217, v217, v51
  v_mul_f32 v218, v218, v52
  v_mul_f32 v219, v219, v53
  v_mfma_f32_32x32x16_bf16 v[66:81], a[160:163], a[144:147], v[66:81]
  ds_read_b64_tr_b16 a[184:185], v136 offset:40960
  ds_read_b64_tr_b16 a[186:187], v136 offset:41984
  buffer_load_dwordx4 v165, s[32:35], s54 offen offset:3072 lds
  buffer_load_dword v235, v206, s[36:39], 0 offen offset:768 sc1
  v_mfma_f32_16x16x32_bf16 v[170:173], v[166:169], a[160:163], v[170:173]
  v_exp_f32 v216, v216
  v_mfma_f32_32x32x16_bf16 v[82:97], a[164:167], a[144:147], v[82:97]
  s_waitcnt lgkmcnt(6)
  ds_read_b64_tr_b16 a[188:189], v137 offset:40960
  ds_read_b64_tr_b16 a[190:191], v137 offset:41984
  v_exp_f32 v217, v217
  v_exp_f32 v218, v218
  v_mfma_f32_32x32x16_bf16 v[66:81], a[168:171], a[148:151], v[66:81]
  s_waitcnt vmcnt(18)
  s_barrier
  ds_read_b64_tr_b16 a[160:161], v138 offset:0
  ds_read_b64_tr_b16 a[162:163], v138 offset:1024
  buffer_load_dword v236, v206, s[36:39], 0 offen offset:1024 sc1
  v_mfma_f32_32x32x16_bf16 v[82:97], a[172:175], a[148:151], v[82:97]
  s_waitcnt lgkmcnt(6)
  ds_read_b64_tr_b16 a[164:165], v139 offset:0
  ds_read_b64_tr_b16 a[166:167], v139 offset:1024
  v_exp_f32 v219, v219
  v_fma_f32 v216, v216, v202, v202
  v_fma_f32 v217, v217, v202, v202
  v_mfma_f32_32x32x16_bf16 v[66:81], a[176:179], a[152:155], v[66:81]
  ds_read_b64_tr_b16 a[168:169], v142 offset:0
  ds_read_b64_tr_b16 a[170:171], v142 offset:1024
  s_add_u32 m0, s56, 16384
  s_mul_i32 s54, s64, 491520
  buffer_load_dwordx4 v162, s[32:35], s54 offen offset:0 lds
  buffer_load_dword v237, v206, s[36:39], 0 offen offset:1280 sc1
  v_mfma_f32_16x16x32_bf16 v[170:173], v[166:169], a[176:179], v[170:173]
  v_fma_f32 v218, v218, v202, v202
  v_mfma_f32_32x32x16_bf16 v[82:97], a[180:183], a[152:155], v[82:97]
  s_waitcnt lgkmcnt(6)
  ds_read_b64_tr_b16 a[172:173], v143 offset:0
  ds_read_b64_tr_b16 a[174:175], v143 offset:1024
  v_fma_f32 v219, v219, v202, v202
  v_rcp_f32 v216, v216
  v_mfma_f32_32x32x16_bf16 v[66:81], a[184:187], a[156:159], v[66:81]
  ds_read_b64_tr_b16 a[176:177], v138 offset:8192
  ds_read_b64_tr_b16 a[178:179], v138 offset:9216
  buffer_load_dword v238, v206, s[36:39], 0 offen offset:1536 sc1
  v_rcp_f32 v217, v217
  v_mfma_f32_32x32x16_bf16 v[82:97], a[188:191], a[156:159], v[82:97]
  s_waitcnt lgkmcnt(6)
  ds_read_b64_tr_b16 a[180:181], v139 offset:8192
  ds_read_b64_tr_b16 a[182:183], v139 offset:9216
  v_rcp_f32 v218, v218
  v_rcp_f32 v219, v219
  v_mfma_f32_32x32x16_bf16 v[98:113], a[160:163], a[0:3], 0
  ds_read_b64_tr_b16 a[184:185], v142 offset:8192
  ds_read_b64_tr_b16 a[186:187], v142 offset:9216
  buffer_load_dwordx4 v163, s[32:35], s54 offen offset:1024 lds
  buffer_load_dword v239, v206, s[36:39], 0 offen offset:1792 sc1
  v_mul_f32 v50, v50, v216
  v_mfma_f32_16x16x32_bf16 v[174:177], v[166:169], a[160:163], 0
  v_mul_f32 v51, v51, v217
  v_mul_f32 v52, v52, v218
  v_mfma_f32_32x32x16_bf16 v[114:129], a[164:167], a[0:3], 0
  s_waitcnt lgkmcnt(6)
  ds_read_b64_tr_b16 a[188:189], v143 offset:8192
  ds_read_b64_tr_b16 a[190:191], v143 offset:9216
  v_cvt_pk_bf16_f32 v171, v170, v170
  v_and_b32 v172, 0xffff0000, v171
  v_sub_f32 v172, v170, v172
  v_cvt_pk_bf16_f32 v170, v170, v172
  v_and_b32 v171, 0xffff, v171
  v_mfma_f32_32x32x16_bf16 v[98:113], a[168:171], a[4:7], v[98:113]
  ds_write_b64 v207, v[170:171] offset:512
  ds_read_b64_tr_b16 a[160:161], v140 offset:0
  ds_read_b64_tr_b16 a[162:163], v140 offset:1024
  buffer_load_dword v240, v206, s[36:39], 0 offen offset:2048 sc1
  v_mul_f32 v53, v53, v219
  v_mfma_f32_32x32x16_bf16 v[114:129], a[172:175], a[4:7], v[114:129]
  s_waitcnt lgkmcnt(7)
  ds_read_b64_tr_b16 a[164:165], v141 offset:0
  ds_read_b64_tr_b16 a[166:167], v141 offset:1024
  v_cvt_pk_bf16_f32 v50, v50, v51
  v_cvt_pk_bf16_f32 v51, v52, v53
  v_mul_f32 v216, v54, v54
  v_mul_f32 v217, v55, v55
  v_mfma_f32_32x32x16_bf16 v[98:113], a[176:179], a[8:11], v[98:113]
  ds_read_b64_tr_b16 a[168:169], v144 offset:0
  ds_read_b64_tr_b16 a[170:171], v144 offset:1024
  buffer_load_dwordx4 v164, s[32:35], s54 offen offset:2048 lds
  buffer_load_dword v241, v206, s[36:39], 0 offen offset:2304 sc1
  v_mul_f32 v218, v56, v56
  v_mfma_f32_16x16x32_bf16 v[174:177], v[166:169], a[176:179], v[174:177]
  v_mul_f32 v219, v57, v57
  v_fma_f32 v216, v216, v201, v200
  v_mfma_f32_32x32x16_bf16 v[114:129], a[180:183], a[8:11], v[114:129]
  s_waitcnt lgkmcnt(6)
  s_barrier
  ds_read_b64 v[192:193], v196 offset:512
  ds_read_b64 v[194:195], v197 offset:512
  ds_read_b64_tr_b16 a[172:173], v145 offset:0
  ds_read_b64_tr_b16 a[174:175], v145 offset:1024
  v_fma_f32 v217, v217, v201, v200
  v_mfma_f32_32x32x16_bf16 v[98:113], a[184:187], a[12:15], v[98:113]
  ds_read_b64_tr_b16 a[176:177], v140 offset:8192
  ds_read_b64_tr_b16 a[178:179], v140 offset:9216
  buffer_load_dword v242, v206, s[36:39], 0 offen offset:2560 sc1
  v_fma_f32 v218, v218, v201, v200
  v_fma_f32 v219, v219, v201, v200
  v_mul_f32 v216, v216, v54
  v_mfma_f32_32x32x16_bf16 v[114:129], a[188:191], a[12:15], v[114:129]
  s_waitcnt lgkmcnt(8)
  ds_read_b64_tr_b16 a[180:181], v141 offset:8192
  ds_read_b64_tr_b16 a[182:183], v141 offset:9216
  v_mul_f32 v217, v217, v55
  v_mul_f32 v218, v218, v56
  v_mul_f32 v219, v219, v57
  v_mfma_f32_32x32x16_bf16 v[98:113], a[160:163], a[16:19], v[98:113]
  s_waitcnt lgkmcnt(6)
  ds_read_b64_tr_b16 a[184:185], v144 offset:8192
  ds_read_b64_tr_b16 a[186:187], v144 offset:9216
  buffer_load_dwordx4 v165, s[32:35], s54 offen offset:3072 lds
  buffer_load_dword v243, v206, s[36:39], 0 offen offset:2816 sc1
  v_mfma_f32_16x16x32_bf16 v[174:177], v[166:169], a[160:163], v[174:177]
  v_exp_f32 v216, v216
  s_nop 1
  v_mfma_f32_32x32x8_bf16 v[66:81], v[192:193], v[190:191], v[66:81]
  v_exp_f32 v217, v217
  v_exp_f32 v218, v218
  v_mfma_f32_32x32x16_bf16 v[114:129], a[164:167], a[16:19], v[114:129]
  s_waitcnt lgkmcnt(6)
  ds_read_b64_tr_b16 a[188:189], v145 offset:8192
  ds_read_b64_tr_b16 a[190:191], v145 offset:9216
  v_exp_f32 v219, v219
  v_fma_f32 v216, v216, v202, v202
  v_fma_f32 v217, v217, v202, v202
  s_nop 1
  v_mfma_f32_32x32x8_bf16 v[82:97], v[194:195], v[190:191], v[82:97]
  v_fma_f32 v218, v218, v202, v202
  v_fma_f32 v219, v219, v202, v202
  v_rcp_f32 v216, v216
  v_mfma_f32_32x32x16_bf16 v[98:113], a[168:171], a[20:23], v[98:113]
  s_waitcnt vmcnt(26)
  s_barrier
  ds_read_b64_tr_b16 a[160:161], v138 offset:16384
  ds_read_b64_tr_b16 a[162:163], v138 offset:17408
  buffer_load_dword v244, v206, s[36:39], 0 offen offset:3072 sc1
  v_mfma_f32_32x32x16_bf16 v[114:129], a[172:175], a[20:23], v[114:129]
  s_waitcnt lgkmcnt(6)
  ds_read_b64_tr_b16 a[164:165], v139 offset:16384
  ds_read_b64_tr_b16 a[166:167], v139 offset:17408
  v_rcp_f32 v217, v217
  v_rcp_f32 v218, v218
  v_mfma_f32_32x32x16_bf16 v[98:113], a[176:179], a[24:27], v[98:113]
  ds_read_b64_tr_b16 a[168:169], v142 offset:16384
  ds_read_b64_tr_b16 a[170:171], v142 offset:17408
  buffer_load_dword v245, v206, s[36:39], 0 offen offset:3328 sc1
  v_rcp_f32 v219, v219
  v_mul_f32 v54, v54, v216
  v_mfma_f32_16x16x32_bf16 v[174:177], v[166:169], a[176:179], v[174:177]
  v_mul_f32 v55, v55, v217
  v_mul_f32 v56, v56, v218
  v_mfma_f32_32x32x16_bf16 v[114:129], a[180:183], a[24:27], v[114:129]
  s_waitcnt lgkmcnt(6)
  ds_read_b64_tr_b16 a[172:173], v143 offset:16384
  ds_read_b64_tr_b16 a[174:175], v143 offset:17408
  v_mul_f32 v57, v57, v219
  v_cvt_pk_bf16_f32 v52, v54, v55
  v_cvt_pk_bf16_f32 v53, v56, v57
  v_mfma_f32_32x32x16_bf16 v[98:113], a[184:187], a[28:31], v[98:113]
  ds_read_b64_tr_b16 a[176:177], v138 offset:24576
  ds_read_b64_tr_b16 a[178:179], v138 offset:25600
  buffer_load_dword v255, v253, s[36:39], 0 offen
  v_mfma_f32_32x32x16_bf16 v[114:129], a[188:191], a[28:31], v[114:129]
  s_waitcnt lgkmcnt(6)
  ds_read_b64_tr_b16 a[180:181], v139 offset:24576
  ds_read_b64_tr_b16 a[182:183], v139 offset:25600
  buffer_store_dwordx4 v[50:53], v153, s[36:39], 0 offen offset:0 sc0 sc1
  v_mfma_f32_32x32x16_bf16 v[98:113], a[160:163], a[32:35], v[98:113]
  ds_read_b64_tr_b16 a[184:185], v142 offset:24576
  ds_read_b64_tr_b16 a[186:187], v142 offset:25600
  s_and_b32 s53, s2, 7
  s_lshl_b32 s53, s53, 20
  v_mov_b32 v254, s53
  global_load_dword v255, v254, s[18:19]
  v_mfma_f32_16x16x32_bf16 v[174:177], v[166:169], a[160:163], v[174:177]
  v_mul_f32 v216, v58, v58
  v_mfma_f32_32x32x16_bf16 v[114:129], a[164:167], a[32:35], v[114:129]
  s_waitcnt lgkmcnt(6)
  ds_read_b64_tr_b16 a[188:189], v143 offset:24576
  ds_read_b64_tr_b16 a[190:191], v143 offset:25600
  v_mov_b32 v254, 0
  global_load_dword v255, v254, s[20:21]
  v_mul_f32 v217, v59, v59
  v_mul_f32 v218, v60, v60
  v_mfma_f32_32x32x16_bf16 v[98:113], a[168:171], a[36:39], v[98:113]
  ds_read_b64_tr_b16 a[160:161], v140 offset:16384
  ds_read_b64_tr_b16 a[162:163], v140 offset:17408
  v_lshlrev_b32 v254, 6, v0
  v_add_u32 v254, k2_go-k1_pc, v254
  global_load_dword v255, v254, s[96:97]
  v_mul_f32 v219, v61, v61
  v_fma_f32 v216, v216, v201, v200
  v_mfma_f32_32x32x16_bf16 v[114:129], a[172:175], a[36:39], v[114:129]
  s_waitcnt lgkmcnt(6)
  ds_read_b64_tr_b16 a[164:165], v141 offset:16384
  ds_read_b64_tr_b16 a[166:167], v141 offset:17408
  v_fma_f32 v217, v217, v201, v200
  v_fma_f32 v218, v218, v201, v200
  v_fma_f32 v219, v219, v201, v200
  v_mul_f32 v216, v216, v58
  v_mfma_f32_32x32x16_bf16 v[98:113], a[176:179], a[40:43], v[98:113]
  ds_read_b64_tr_b16 a[168:169], v144 offset:16384
  ds_read_b64_tr_b16 a[170:171], v144 offset:17408
  v_mul_f32 v217, v217, v59
  v_mul_f32 v218, v218, v60
  v_mul_f32 v219, v219, v61
  v_exp_f32 v216, v216
  v_mfma_f32_16x16x32_bf16 v[174:177], v[166:169], a[176:179], v[174:177]
  v_exp_f32 v217, v217
  v_mfma_f32_32x32x16_bf16 v[114:129], a[180:183], a[40:43], v[114:129]
  s_waitcnt lgkmcnt(6)
  ds_read_b64_tr_b16 a[172:173], v145 offset:16384
  ds_read_b64_tr_b16 a[174:175], v145 offset:17408
  v_exp_f32 v218, v218
  v_exp_f32 v219, v219
  v_mfma_f32_32x32x16_bf16 v[98:113], a[184:187], a[44:47], v[98:113]
  ds_read_b64_tr_b16 a[176:177], v140 offset:24576
  ds_read_b64_tr_b16 a[178:179], v140 offset:25600
  v_fma_f32 v216, v216, v202, v202
  v_fma_f32 v217, v217, v202, v202
  v_fma_f32 v218, v218, v202, v202
  v_fma_f32 v219, v219, v202, v202
  v_mfma_f32_32x32x16_bf16 v[114:129], a[188:191], a[44:47], v[114:129]
  s_waitcnt lgkmcnt(6)
  ds_read_b64_tr_b16 a[180:181], v141 offset:24576
  ds_read_b64_tr_b16 a[182:183], v141 offset:25600
  v_rcp_f32 v216, v216
  v_rcp_f32 v217, v217
  v_mfma_f32_32x32x16_bf16 v[98:113], a[160:163], a[48:51], v[98:113]
  ds_read_b64_tr_b16 a[184:185], v144 offset:24576
  ds_read_b64_tr_b16 a[186:187], v144 offset:25600
  v_rcp_f32 v218, v218
  v_rcp_f32 v219, v219
  v_mul_f32 v58, v58, v216
  v_mfma_f32_16x16x32_bf16 v[174:177], v[166:169], a[160:163], v[174:177]
  v_mul_f32 v59, v59, v217
  v_mul_f32 v60, v60, v218
  v_mfma_f32_32x32x16_bf16 v[114:129], a[164:167], a[48:51], v[114:129]
  s_waitcnt lgkmcnt(6)
  ds_read_b64_tr_b16 a[188:189], v145 offset:24576
  ds_read_b64_tr_b16 a[190:191], v145 offset:25600
  v_mul_f32 v61, v61, v219
  v_cvt_pk_bf16_f32 v54, v58, v59
  v_cvt_pk_bf16_f32 v55, v60, v61
  v_mul_f32 v216, v62, v62
  v_mfma_f32_32x32x16_bf16 v[98:113], a[168:171], a[52:55], v[98:113]
  s_waitcnt vmcnt(28)
  s_barrier
  ds_read_b64_tr_b16 a[160:161], v138 offset:32768
  ds_read_b64_tr_b16 a[162:163], v138 offset:33792
  v_mul_f32 v217, v63, v63
  v_mul_f32 v218, v64, v64
  v_mul_f32 v219, v65, v65
  v_mfma_f32_32x32x16_bf16 v[114:129], a[172:175], a[52:55], v[114:129]
  s_waitcnt lgkmcnt(6)
  ds_read_b64_tr_b16 a[164:165], v139 offset:32768
  ds_read_b64_tr_b16 a[166:167], v139 offset:33792
  v_fma_f32 v216, v216, v201, v200
  v_fma_f32 v217, v217, v201, v200
  v_fma_f32 v218, v218, v201, v200
  v_fma_f32 v219, v219, v201, v200
  v_mfma_f32_32x32x16_bf16 v[98:113], a[176:179], a[56:59], v[98:113]
  ds_read_b64_tr_b16 a[168:169], v142 offset:32768
  ds_read_b64_tr_b16 a[170:171], v142 offset:33792
  v_mul_f32 v216, v216, v62
  v_mul_f32 v217, v217, v63
  v_mul_f32 v218, v218, v64
  v_mul_f32 v219, v219, v65
  v_mfma_f32_16x16x32_bf16 v[174:177], v[166:169], a[176:179], v[174:177]
  v_exp_f32 v216, v216
  v_mfma_f32_32x32x16_bf16 v[114:129], a[180:183], a[56:59], v[114:129]
  s_waitcnt lgkmcnt(6)
  ds_read_b64_tr_b16 a[172:173], v143 offset:32768
  ds_read_b64_tr_b16 a[174:175], v143 offset:33792
  v_exp_f32 v217, v217
  v_exp_f32 v218, v218
  v_mfma_f32_32x32x16_bf16 v[98:113], a[184:187], a[60:63], v[98:113]
  ds_read_b64_tr_b16 a[176:177], v138 offset:40960
  ds_read_b64_tr_b16 a[178:179], v138 offset:41984
  v_exp_f32 v219, v219
  v_fma_f32 v216, v216, v202, v202
  v_fma_f32 v217, v217, v202, v202
  v_fma_f32 v218, v218, v202, v202
  v_mfma_f32_32x32x16_bf16 v[114:129], a[188:191], a[60:63], v[114:129]
  s_waitcnt lgkmcnt(6)
  ds_read_b64_tr_b16 a[180:181], v139 offset:40960
  ds_read_b64_tr_b16 a[182:183], v139 offset:41984
  v_fma_f32 v219, v219, v202, v202
  v_rcp_f32 v216, v216
  v_mfma_f32_32x32x16_bf16 v[98:113], a[160:163], a[64:67], v[98:113]
  ds_read_b64_tr_b16 a[184:185], v142 offset:40960
  ds_read_b64_tr_b16 a[186:187], v142 offset:41984
  v_rcp_f32 v217, v217
  v_rcp_f32 v218, v218
  v_mfma_f32_16x16x32_bf16 v[174:177], v[166:169], a[160:163], v[174:177]
  v_rcp_f32 v219, v219
  v_mfma_f32_32x32x16_bf16 v[114:129], a[164:167], a[64:67], v[114:129]
  s_waitcnt lgkmcnt(6)
  ds_read_b64_tr_b16 a[188:189], v143 offset:40960
  ds_read_b64_tr_b16 a[190:191], v143 offset:41984
  v_mul_f32 v62, v62, v216
  v_mul_f32 v63, v63, v217
  v_mul_f32 v64, v64, v218
  v_mul_f32 v65, v65, v219
  v_mfma_f32_32x32x16_bf16 v[98:113], a[168:171], a[68:71], v[98:113]
  ds_read_b64_tr_b16 a[160:161], v140 offset:32768
  ds_read_b64_tr_b16 a[162:163], v140 offset:33792
  v_cvt_pk_bf16_f32 v56, v62, v63
  v_cvt_pk_bf16_f32 v57, v64, v65
  v_mfma_f32_32x32x16_bf16 v[114:129], a[172:175], a[68:71], v[114:129]
  s_waitcnt lgkmcnt(6)
  ds_read_b64_tr_b16 a[164:165], v141 offset:32768
  ds_read_b64_tr_b16 a[166:167], v141 offset:33792
  buffer_store_dwordx4 v[54:57], v153, s[36:39], 0 offen offset:1024 sc0 sc1
  v_mfma_f32_32x32x16_bf16 v[98:113], a[176:179], a[72:75], v[98:113]
  ds_read_b64_tr_b16 a[168:169], v144 offset:32768
  ds_read_b64_tr_b16 a[170:171], v144 offset:33792
  v_mul_f32 v66, v66, v211
  v_mul_f32 v67, v67, v211
  v_mul_f32 v68, v68, v211
  v_mfma_f32_16x16x32_bf16 v[174:177], v[166:169], a[176:179], v[174:177]
  v_mul_f32 v69, v69, v211
  v_mul_f32 v70, v70, v211
  v_mfma_f32_32x32x16_bf16 v[114:129], a[180:183], a[72:75], v[114:129]
  s_waitcnt lgkmcnt(6)
  ds_read_b64_tr_b16 a[172:173], v145 offset:32768
  ds_read_b64_tr_b16 a[174:175], v145 offset:33792
  v_mul_f32 v71, v71, v211
  v_mul_f32 v72, v72, v211
  v_mul_f32 v73, v73, v211
  v_cvt_pk_bf16_f32 v66, v66, v67
  v_mfma_f32_32x32x16_bf16 v[98:113], a[184:187], a[76:79], v[98:113]
  ds_read_b64_tr_b16 a[176:177], v140 offset:40960
  ds_read_b64_tr_b16 a[178:179], v140 offset:41984
  v_cvt_pk_bf16_f32 v67, v68, v69
  v_cvt_pk_bf16_f32 v68, v70, v71
  v_cvt_pk_bf16_f32 v69, v72, v73
  v_mfma_f32_32x32x16_bf16 v[114:129], a[188:191], a[76:79], v[114:129]
  s_waitcnt lgkmcnt(6)
  ds_read_b64_tr_b16 a[180:181], v141 offset:40960
  ds_read_b64_tr_b16 a[182:183], v141 offset:41984
  buffer_store_dwordx4 v[66:69], v220, s[36:39], 0 offen offset:0 sc0 sc1
  v_mfma_f32_32x32x16_bf16 v[98:113], a[160:163], a[80:83], v[98:113]
  ds_read_b64_tr_b16 a[184:185], v144 offset:40960
  ds_read_b64_tr_b16 a[186:187], v144 offset:41984
  v_mul_f32 v74, v74, v211
  v_mul_f32 v75, v75, v211
  v_mul_f32 v76, v76, v211
  v_mfma_f32_16x16x32_bf16 v[174:177], v[166:169], a[160:163], v[174:177]
  v_mul_f32 v77, v77, v211
  v_mul_f32 v78, v78, v211
  v_mfma_f32_32x32x16_bf16 v[114:129], a[164:167], a[80:83], v[114:129]
  s_waitcnt lgkmcnt(6)
  ds_read_b64_tr_b16 a[188:189], v145 offset:40960
  ds_read_b64_tr_b16 a[190:191], v145 offset:41984
  v_mul_f32 v79, v79, v211
  v_mul_f32 v80, v80, v211
  v_mul_f32 v81, v81, v211
  v_cvt_pk_bf16_f32 v70, v74, v75
  v_mfma_f32_32x32x16_bf16 v[98:113], a[168:171], a[84:87], v[98:113]
  s_waitcnt vmcnt(22)
  s_barrier
  ds_read_b64_tr_b16 a[160:161], v130 offset:0
  ds_read_b64_tr_b16 a[162:163], v130 offset:1024
  v_cvt_pk_bf16_f32 v71, v76, v77
  v_cvt_pk_bf16_f32 v72, v78, v79
  v_cvt_pk_bf16_f32 v73, v80, v81
  v_mfma_f32_32x32x16_bf16 v[114:129], a[172:175], a[84:87], v[114:129]
  s_waitcnt lgkmcnt(6)
  ds_read_b64_tr_b16 a[164:165], v131 offset:0
  ds_read_b64_tr_b16 a[166:167], v131 offset:1024
  buffer_store_dwordx4 v[70:73], v220, s[36:39], 0 offen offset:1024 sc0 sc1
  v_mfma_f32_32x32x16_bf16 v[98:113], a[176:179], a[88:91], v[98:113]
  ds_read_b64_tr_b16 a[168:169], v134 offset:0
  ds_read_b64_tr_b16 a[170:171], v134 offset:1024
  v_mul_f32 v82, v82, v211
  v_mul_f32 v83, v83, v211
  v_mul_f32 v84, v84, v211
  v_mfma_f32_16x16x32_bf16 v[174:177], v[166:169], a[176:179], v[174:177]
  v_mul_f32 v85, v85, v211
  v_mul_f32 v86, v86, v211
  v_mfma_f32_32x32x16_bf16 v[114:129], a[180:183], a[88:91], v[114:129]
  s_waitcnt lgkmcnt(6)
  ds_read_b64_tr_b16 a[172:173], v135 offset:0
  ds_read_b64_tr_b16 a[174:175], v135 offset:1024
  v_mul_f32 v87, v87, v211
  v_mul_f32 v88, v88, v211
  v_mul_f32 v89, v89, v211
  v_cvt_pk_bf16_f32 v82, v82, v83
  v_mfma_f32_32x32x16_bf16 v[98:113], a[184:187], a[92:95], v[98:113]
  ds_read_b64_tr_b16 a[176:177], v130 offset:8192
  ds_read_b64_tr_b16 a[178:179], v130 offset:9216
  v_cvt_pk_bf16_f32 v83, v84, v85
  v_cvt_pk_bf16_f32 v84, v86, v87
  v_cvt_pk_bf16_f32 v85, v88, v89
  v_mfma_f32_32x32x16_bf16 v[114:129], a[188:191], a[92:95], v[114:129]
  s_waitcnt lgkmcnt(6)
  ds_read_b64_tr_b16 a[180:181], v131 offset:8192
  ds_read_b64_tr_b16 a[182:183], v131 offset:9216
  buffer_store_dwordx4 v[82:85], v221, s[36:39], 0 offen offset:0 sc0 sc1
  v_mfma_f32_32x32x16_bf16 v[98:113], a[160:163], a[96:99], v[98:113]
  ds_read_b64_tr_b16 a[184:185], v134 offset:8192
  ds_read_b64_tr_b16 a[186:187], v134 offset:9216
  v_mul_f32 v90, v90, v211
  v_mul_f32 v91, v91, v211
  v_mul_f32 v92, v92, v211
  v_mfma_f32_16x16x32_bf16 v[174:177], v[166:169], a[160:163], v[174:177]
  v_mul_f32 v93, v93, v211
  v_mul_f32 v94, v94, v211
  v_mfma_f32_32x32x16_bf16 v[114:129], a[164:167], a[96:99], v[114:129]
  s_waitcnt lgkmcnt(6)
  ds_read_b64_tr_b16 a[188:189], v135 offset:8192
  ds_read_b64_tr_b16 a[190:191], v135 offset:9216
  v_mul_f32 v95, v95, v211
  v_mul_f32 v96, v96, v211
  v_mul_f32 v97, v97, v211
  v_cvt_pk_bf16_f32 v86, v90, v91
  v_mfma_f32_32x32x16_bf16 v[98:113], a[168:171], a[100:103], v[98:113]
  ds_read_b64_tr_b16 a[160:161], v132 offset:0
  ds_read_b64_tr_b16 a[162:163], v132 offset:1024
  v_cvt_pk_bf16_f32 v87, v92, v93
  v_cvt_pk_bf16_f32 v88, v94, v95
  v_cvt_pk_bf16_f32 v89, v96, v97
  v_mfma_f32_32x32x16_bf16 v[114:129], a[172:175], a[100:103], v[114:129]
  s_waitcnt lgkmcnt(6)
  ds_read_b64_tr_b16 a[164:165], v133 offset:0
  ds_read_b64_tr_b16 a[166:167], v133 offset:1024
  buffer_store_dwordx4 v[86:89], v221, s[36:39], 0 offen offset:1024 sc0 sc1
  v_mfma_f32_32x32x16_bf16 v[98:113], a[176:179], a[104:107], v[98:113]
  ds_read_b64_tr_b16 a[168:169], v136 offset:0
  ds_read_b64_tr_b16 a[170:171], v136 offset:1024
  v_mfma_f32_16x16x32_bf16 v[174:177], v[166:169], a[176:179], v[174:177]
  v_mfma_f32_32x32x16_bf16 v[114:129], a[180:183], a[104:107], v[114:129]
  s_waitcnt lgkmcnt(6)
  ds_read_b64_tr_b16 a[172:173], v137 offset:0
  ds_read_b64_tr_b16 a[174:175], v137 offset:1024
  s_waitcnt vmcnt(10)
k1_s0:
  v_max_u32 v216, v232, v233
  v_max3_u32 v216, v234, v235, v216
  v_max3_u32 v216, v236, v237, v216
  v_max3_u32 v216, v238, v239, v216
  v_max3_u32 v216, v240, v241, v216
  v_max3_u32 v216, v242, v243, v216
  v_max3_u32 v216, v244, v245, v216
  v_cmp_eq_u32 vcc, -1, v216
  s_nop 1
  s_cbranch_vccz k1_s1
  s_add_u32 s59, s59, 0x4000
  s_cbranch_scc1 k1_s1
  buffer_load_dword v232, v206, s[36:39], 0 offen offset:0 sc1
  buffer_load_dword v233, v206, s[36:39], 0 offen offset:256 sc1
  buffer_load_dword v234, v206, s[36:39], 0 offen offset:512 sc1
  buffer_load_dword v235, v206, s[36:39], 0 offen offset:768 sc1
  buffer_load_dword v236, v206, s[36:39], 0 offen offset:1024 sc1
  buffer_load_dword v237, v206, s[36:39], 0 offen offset:1280 sc1
  buffer_load_dword v238, v206, s[36:39], 0 offen offset:1536 sc1
  buffer_load_dword v239, v206, s[36:39], 0 offen offset:1792 sc1
  buffer_load_dword v240, v206, s[36:39], 0 offen offset:2048 sc1
  buffer_load_dword v241, v206, s[36:39], 0 offen offset:2304 sc1
  buffer_load_dword v242, v206, s[36:39], 0 offen offset:2560 sc1
  buffer_load_dword v243, v206, s[36:39], 0 offen offset:2816 sc1
  buffer_load_dword v244, v206, s[36:39], 0 offen offset:3072 sc1
  buffer_load_dword v245, v206, s[36:39], 0 offen offset:3328 sc1
  s_waitcnt vmcnt(0)
  s_branch k1_s0
k1_s1:
  v_mfma_f32_32x32x16_bf16 v[98:113], a[184:187], a[108:111], v[98:113]
  ds_read_b64_tr_b16 a[176:177], v132 offset:8192
  ds_read_b64_tr_b16 a[178:179], v132 offset:9216
  v_mfma_f32_32x32x16_bf16 v[114:129], a[188:191], a[108:111], v[114:129]
  s_waitcnt lgkmcnt(6)
  ds_read_b64_tr_b16 a[180:181], v133 offset:8192
  ds_read_b64_tr_b16 a[182:183], v133 offset:9216
  v_add_f32 v232, v232, v239
  v_add_f32 v233, v233, v240
  v_mfma_f32_32x32x16_bf16 v[98:113], a[160:163], a[112:115], v[98:113]
  ds_read_b64_tr_b16 a[184:185], v136 offset:8192
  ds_read_b64_tr_b16 a[186:187], v136 offset:9216
  v_add_f32 v234, v234, v241
  v_add_f32 v235, v235, v242
  v_add_f32 v236, v236, v243
  v_add_f32 v237, v237, v244
  v_add_f32 v238, v238, v245
  v_mfma_f32_16x16x32_bf16 v[174:177], v[166:169], a[160:163], v[174:177]
  v_add_f32 v232, v232, v233
  v_add_f32 v234, v234, v235
  v_mfma_f32_32x32x16_bf16 v[114:129], a[164:167], a[112:115], v[114:129]
  s_waitcnt lgkmcnt(6)
  ds_read_b64_tr_b16 a[188:189], v137 offset:8192
  ds_read_b64_tr_b16 a[190:191], v137 offset:9216
  v_add_f32 v236, v236, v237
  v_add_f32 v232, v232, v238
  v_add_f32 v234, v234, v236
  v_add_f32 v232, v232, v234
  v_mfma_f32_32x32x16_bf16 v[98:113], a[168:171], a[116:119], v[98:113]
  s_barrier
  ds_read_b64_tr_b16 a[160:161], v130 offset:16384
  ds_read_b64_tr_b16 a[162:163], v130 offset:17408
  v_mul_f32 v216, 0x3a97b426, v232
  v_mov_b32 v217, v216
  s_nop 1
  v_permlane32_swap_b32 v216, v217
  v_mfma_f32_32x32x16_bf16 v[114:129], a[172:175], a[116:119], v[114:129]
  s_waitcnt lgkmcnt(6)
  ds_read_b64_tr_b16 a[164:165], v131 offset:16384
  ds_read_b64_tr_b16 a[166:167], v131 offset:17408
  s_nop 1
  v_fma_f32 v217, -v216, v216, v217
  v_max_f32 v217, 0, v217
  v_add_f32 v217, 0x3727c5ac, v217
  v_mfma_f32_32x32x16_bf16 v[98:113], a[176:179], a[120:123], v[98:113]
  ds_read_b64_tr_b16 a[168:169], v134 offset:16384
  ds_read_b64_tr_b16 a[170:171], v134 offset:17408
  v_rsq_f32 v218, v217
  s_nop 0
  v_mul_f32 v216, v216, v218
  v_fma_f32 v2, v2, v218, -v216
  v_fma_f32 v3, v3, v218, -v216
  v_mfma_f32_16x16x32_bf16 v[174:177], v[166:169], a[176:179], v[174:177]
  v_fma_f32 v4, v4, v218, -v216
  v_fma_f32 v5, v5, v218, -v216
  v_mfma_f32_32x32x16_bf16 v[114:129], a[180:183], a[120:123], v[114:129]
  s_waitcnt lgkmcnt(6)
  ds_read_b64_tr_b16 a[172:173], v135 offset:16384
  ds_read_b64_tr_b16 a[174:175], v135 offset:17408
  v_fma_f32 v6, v6, v218, -v216
  v_fma_f32 v7, v7, v218, -v216
  v_fma_f32 v8, v8, v218, -v216
  v_fma_f32 v9, v9, v218, -v216
  v_mfma_f32_32x32x16_bf16 v[98:113], a[184:187], a[124:127], v[98:113]
  ds_read_b64_tr_b16 a[176:177], v130 offset:24576
  ds_read_b64_tr_b16 a[178:179], v130 offset:25600
  v_cvt_pk_bf16_f32 v2, v2, v3
  v_cvt_pk_bf16_f32 v3, v4, v5
  v_cvt_pk_bf16_f32 v4, v6, v7
  v_cvt_pk_bf16_f32 v5, v8, v9
  v_mfma_f32_32x32x16_bf16 v[114:129], a[188:191], a[124:127], v[114:129]
  s_waitcnt lgkmcnt(6)
  ds_read_b64_tr_b16 a[180:181], v131 offset:24576
  ds_read_b64_tr_b16 a[182:183], v131 offset:25600
  ds_write_b128 v208, v[2:5] offset:8192
  v_fma_f32 v10, v10, v218, -v216
  v_fma_f32 v11, v11, v218, -v216
  v_mfma_f32_32x32x16_bf16 v[98:113], a[160:163], a[128:131], v[98:113]
  ds_read_b64_tr_b16 a[184:185], v134 offset:24576
  ds_read_b64_tr_b16 a[186:187], v134 offset:25600
  v_fma_f32 v12, v12, v218, -v216
  v_fma_f32 v13, v13, v218, -v216
  v_fma_f32 v14, v14, v218, -v216
  v_fma_f32 v15, v15, v218, -v216
  v_fma_f32 v16, v16, v218, -v216
  v_mfma_f32_16x16x32_bf16 v[174:177], v[166:169], a[160:163], v[174:177]
  v_fma_f32 v17, v17, v218, -v216
  v_cvt_pk_bf16_f32 v6, v10, v11
  v_mfma_f32_32x32x16_bf16 v[114:129], a[164:167], a[128:131], v[114:129]
  s_waitcnt lgkmcnt(7)
  ds_read_b64_tr_b16 a[188:189], v135 offset:24576
  ds_read_b64_tr_b16 a[190:191], v135 offset:25600
  v_cvt_pk_bf16_f32 v7, v12, v13
  v_cvt_pk_bf16_f32 v8, v14, v15
  v_cvt_pk_bf16_f32 v9, v16, v17
  v_mfma_f32_32x32x16_bf16 v[98:113], a[168:171], a[132:135], v[98:113]
  ds_read_b64_tr_b16 a[160:161], v132 offset:16384
  ds_read_b64_tr_b16 a[162:163], v132 offset:17408
  ds_write_b128 v212, v[6:9] offset:8192
  v_fma_f32 v18, v18, v218, -v216
  v_fma_f32 v19, v19, v218, -v216
  v_fma_f32 v20, v20, v218, -v216
  v_mfma_f32_32x32x16_bf16 v[114:129], a[172:175], a[132:135], v[114:129]
  s_waitcnt lgkmcnt(8)
  ds_read_b64_tr_b16 a[164:165], v133 offset:16384
  ds_read_b64_tr_b16 a[166:167], v133 offset:17408
  v_fma_f32 v21, v21, v218, -v216
  v_fma_f32 v22, v22, v218, -v216
  v_fma_f32 v23, v23, v218, -v216
  v_fma_f32 v24, v24, v218, -v216
  v_mfma_f32_32x32x16_bf16 v[98:113], a[176:179], a[136:139], v[98:113]
  ds_read_b64_tr_b16 a[168:169], v136 offset:16384
  ds_read_b64_tr_b16 a[170:171], v136 offset:17408
  v_fma_f32 v25, v25, v218, -v216
  v_cvt_pk_bf16_f32 v18, v18, v19
  v_cvt_pk_bf16_f32 v19, v20, v21
  v_cvt_pk_bf16_f32 v20, v22, v23
  v_cvt_pk_bf16_f32 v21, v24, v25
  v_mfma_f32_16x16x32_bf16 v[174:177], v[166:169], a[176:179], v[174:177]
  ds_write_b128 v208, v[18:21] offset:10240
  v_mfma_f32_32x32x16_bf16 v[114:129], a[180:183], a[136:139], v[114:129]
  s_waitcnt lgkmcnt(8)
  ds_read_b64_tr_b16 a[172:173], v137 offset:16384
  ds_read_b64_tr_b16 a[174:175], v137 offset:17408
  ds_read_b64_tr_b16 v[10:11], v209 offset:8192
  ds_read_b64_tr_b16 v[12:13], v213 offset:8448
  ds_read_b64_tr_b16 v[14:15], v209 offset:9216
  ds_read_b64_tr_b16 v[16:17], v213 offset:9472
  v_mfma_f32_32x32x16_bf16 v[98:113], a[184:187], a[140:143], v[98:113]
  ds_read_b64_tr_b16 a[176:177], v132 offset:24576
  ds_read_b64_tr_b16 a[178:179], v132 offset:25600
  v_fma_f32 v26, v26, v218, -v216
  v_fma_f32 v27, v27, v218, -v216
  v_fma_f32 v28, v28, v218, -v216
  v_fma_f32 v29, v29, v218, -v216
  v_fma_f32 v30, v30, v218, -v216
  v_mfma_f32_32x32x16_bf16 v[114:129], a[188:191], a[140:143], v[114:129]
  s_waitcnt lgkmcnt(11)
  ds_read_b64_tr_b16 a[180:181], v133 offset:24576
  ds_read_b64_tr_b16 a[182:183], v133 offset:25600
  v_fma_f32 v31, v31, v218, -v216
  v_fma_f32 v32, v32, v218, -v216
  v_fma_f32 v33, v33, v218, -v216
  v_cvt_pk_bf16_f32 v22, v26, v27
  v_mfma_f32_32x32x16_bf16 v[98:113], a[160:163], a[144:147], v[98:113]
  ds_read_b64_tr_b16 a[184:185], v136 offset:24576
  ds_read_b64_tr_b16 a[186:187], v136 offset:25600
  v_cvt_pk_bf16_f32 v23, v28, v29
  v_cvt_pk_bf16_f32 v24, v30, v31
  v_cvt_pk_bf16_f32 v25, v32, v33
  ds_write_b128 v212, v[22:25] offset:10240
  v_mfma_f32_16x16x32_bf16 v[174:177], v[166:169], a[160:163], v[174:177]
  v_mfma_f32_32x32x16_bf16 v[114:129], a[164:167], a[144:147], v[114:129]
  s_waitcnt lgkmcnt(11)
  ds_read_b64_tr_b16 a[188:189], v137 offset:24576
  ds_read_b64_tr_b16 a[190:191], v137 offset:25600
  ds_read_b64_tr_b16 v[26:27], v209 offset:10240
  ds_read_b64_tr_b16 v[28:29], v213 offset:10496
  ds_read_b64_tr_b16 v[30:31], v209 offset:11264
  ds_read_b64_tr_b16 v[32:33], v213 offset:11520
  v_mfma_f32_32x32x16_bf16 v[98:113], a[168:171], a[148:151], v[98:113]
  s_waitcnt lgkmcnt(13)
  buffer_store_dwordx4 v[10:13], v150, s[36:39], 0 offen offset:0 sc0 sc1
  v_mfma_f32_32x32x16_bf16 v[114:129], a[172:175], a[148:151], v[114:129]
  s_waitcnt lgkmcnt(9)
  buffer_store_dwordx4 v[14:17], v150, s[36:39], 0 offen offset:1024 sc0 sc1
  v_mfma_f32_32x32x16_bf16 v[98:113], a[176:179], a[152:155], v[98:113]
  s_waitcnt lgkmcnt(0)
  buffer_store_dwordx4 v[26:29], v151, s[36:39], 0 offen offset:0 sc0 sc1
  v_mfma_f32_16x16x32_bf16 v[174:177], v[166:169], a[176:179], v[174:177]
  v_mfma_f32_32x32x16_bf16 v[114:129], a[180:183], a[152:155], v[114:129]
  buffer_store_dwordx4 v[30:33], v151, s[36:39], 0 offen offset:1024 sc0 sc1
  v_mfma_f32_32x32x16_bf16 v[98:113], a[184:187], a[156:159], v[98:113]
  v_mfma_f32_32x32x16_bf16 v[114:129], a[188:191], a[156:159], v[114:129]
  s_nop 3
  v_cvt_pk_bf16_f32 v175, v174, v174
  v_and_b32 v176, 0xffff0000, v175
  v_sub_f32 v176, v174, v176
  v_cvt_pk_bf16_f32 v174, v174, v176
  v_and_b32 v175, 0xffff, v175
  ds_write_b64 v207, v[174:175] offset:768
  s_waitcnt lgkmcnt(0)
  s_barrier
  ds_read_b64 v[192:193], v196 offset:768
  ds_read_b64 v[194:195], v197 offset:768
  v_and_b32 v216, 19, v198
  v_bfe_u32 v217, v198, 2, 1
  v_bfe_u32 v218, v198, 3, 1
  v_lshl_add_u32 v216, v217, 3, v216
  v_lshl_add_u32 v216, v218, 2, v216
  s_sub_u32 s50, s46, 5
  s_lshl_b32 s50, s50, 1
  s_add_u32 s50, s50, s47
  s_lshl_b32 s50, s50, 5
  v_add_u32 v216, s50, v216
  v_lshrrev_b32 v217, 5, v198
  v_mul_u32_u24 v217, 320, v217
  s_mul_i32 s50, s57, 1280
  s_add_u32 s50, s50, 5505024
  v_add_u32 v217, s50, v217
  v_mov_b32 v200, v203
  v_mov_b32 v201, v203
  s_waitcnt lgkmcnt(0)
  v_mfma_f32_32x32x8_bf16 v[98:113], v[192:193], v[190:191], v[98:113]
  v_mfma_f32_32x32x8_bf16 v[114:129], v[194:195], v[190:191], v[114:129]
  v_xor_b32 v218, 0, v216
  v_mul_u32_u24 v219, 52429, v218
  v_lshrrev_b32 v219, 20, v219
  v_mul_u32_u24 v219, 81600, v219
  v_lshl_add_u32 v218, v218, 4, v219
  v_add_u32 v222, v218, v217
  v_xor_b32 v218, 32, v216
  v_mul_u32_u24 v219, 52429, v218
  v_lshrrev_b32 v219, 20, v219
  v_mul_u32_u24 v219, 81600, v219
  v_lshl_add_u32 v218, v218, 4, v219
  v_add_u32 v223, v218, v217
  s_mov_b32 s50, 61440
  s_cmp_ge_u32 s46, 5
  s_cbranch_scc1 k1_v
  v_pk_mul_f32 v[98:99], v[98:99], v[200:201]
  v_pk_mul_f32 v[100:101], v[100:101], v[200:201]
  v_pk_mul_f32 v[102:103], v[102:103], v[200:201]
  v_pk_mul_f32 v[104:105], v[104:105], v[200:201]
  v_cvt_pk_bf16_f32 v98, v98, v99
  v_cvt_pk_bf16_f32 v99, v100, v101
  v_cvt_pk_bf16_f32 v100, v102, v103
  v_cvt_pk_bf16_f32 v101, v104, v105
  buffer_store_dwordx4 v[98:101], v220, s[36:39], s50 offen offset:0 sc0 sc1
  v_pk_mul_f32 v[106:107], v[106:107], v[200:201]
  v_pk_mul_f32 v[108:109], v[108:109], v[200:201]
  v_pk_mul_f32 v[110:111], v[110:111], v[200:201]
  v_pk_mul_f32 v[112:113], v[112:113], v[200:201]
  v_cvt_pk_bf16_f32 v102, v106, v107
  v_cvt_pk_bf16_f32 v103, v108, v109
  v_cvt_pk_bf16_f32 v104, v110, v111
  v_cvt_pk_bf16_f32 v105, v112, v113
  buffer_store_dwordx4 v[102:105], v220, s[36:39], s50 offen offset:1024 sc0 sc1
  v_pk_mul_f32 v[114:115], v[114:115], v[200:201]
  v_pk_mul_f32 v[116:117], v[116:117], v[200:201]
  v_pk_mul_f32 v[118:119], v[118:119], v[200:201]
  v_pk_mul_f32 v[120:121], v[120:121], v[200:201]
  v_cvt_pk_bf16_f32 v114, v114, v115
  v_cvt_pk_bf16_f32 v115, v116, v117
  v_cvt_pk_bf16_f32 v116, v118, v119
  v_cvt_pk_bf16_f32 v117, v120, v121
  buffer_store_dwordx4 v[114:117], v221, s[36:39], s50 offen offset:0 sc0 sc1
  v_pk_mul_f32 v[122:123], v[122:123], v[200:201]
  v_pk_mul_f32 v[124:125], v[124:125], v[200:201]
  v_pk_mul_f32 v[126:127], v[126:127], v[200:201]
  v_pk_mul_f32 v[128:129], v[128:129], v[200:201]
  v_cvt_pk_bf16_f32 v118, v122, v123
  v_cvt_pk_bf16_f32 v119, v124, v125
  v_cvt_pk_bf16_f32 v120, v126, v127
  v_cvt_pk_bf16_f32 v121, v128, v129
  buffer_store_dwordx4 v[118:121], v221, s[36:39], s50 offen offset:1024 sc0 sc1
  s_branch k1_fin
k1_v:
  v_pk_mul_f32 v[98:99], v[98:99], v[200:201]
  v_pk_mul_f32 v[100:101], v[100:101], v[200:201]
  v_pk_mul_f32 v[102:103], v[102:103], v[200:201]
  v_pk_mul_f32 v[104:105], v[104:105], v[200:201]
  v_cvt_pk_bf16_f32 v98, v98, v99
  v_cvt_pk_bf16_f32 v99, v100, v101
  v_cvt_pk_bf16_f32 v100, v102, v103
  v_cvt_pk_bf16_f32 v101, v104, v105
  ds_write_b128 v208, v[98:101] offset:0
  v_pk_mul_f32 v[106:107], v[106:107], v[200:201]
  v_pk_mul_f32 v[108:109], v[108:109], v[200:201]
  v_pk_mul_f32 v[110:111], v[110:111], v[200:201]
  v_pk_mul_f32 v[112:113], v[112:113], v[200:201]
  v_cvt_pk_bf16_f32 v102, v106, v107
  v_cvt_pk_bf16_f32 v103, v108, v109
  v_cvt_pk_bf16_f32 v104, v110, v111
  v_cvt_pk_bf16_f32 v105, v112, v113
  ds_write_b128 v212, v[102:105] offset:0
  v_pk_mul_f32 v[114:115], v[114:115], v[200:201]
  v_pk_mul_f32 v[116:117], v[116:117], v[200:201]
  v_pk_mul_f32 v[118:119], v[118:119], v[200:201]
  v_pk_mul_f32 v[120:121], v[120:121], v[200:201]
  v_cvt_pk_bf16_f32 v114, v114, v115
  v_cvt_pk_bf16_f32 v115, v116, v117
  v_cvt_pk_bf16_f32 v116, v118, v119
  v_cvt_pk_bf16_f32 v117, v120, v121
  ds_write_b128 v208, v[114:117] offset:2048
  v_pk_mul_f32 v[122:123], v[122:123], v[200:201]
  v_pk_mul_f32 v[124:125], v[124:125], v[200:201]
  v_pk_mul_f32 v[126:127], v[126:127], v[200:201]
  v_pk_mul_f32 v[128:129], v[128:129], v[200:201]
  v_cvt_pk_bf16_f32 v118, v122, v123
  v_cvt_pk_bf16_f32 v119, v124, v125
  v_cvt_pk_bf16_f32 v120, v126, v127
  v_cvt_pk_bf16_f32 v121, v128, v129
  ds_write_b128 v212, v[118:121] offset:2048
  ds_read_b64_tr_b16 v[106:107], v209 offset:0
  ds_read_b64_tr_b16 v[108:109], v213 offset:256
  ds_read_b64_tr_b16 v[110:111], v209 offset:1024
  ds_read_b64_tr_b16 v[112:113], v213 offset:1280
  ds_read_b64_tr_b16 v[122:123], v209 offset:2048
  ds_read_b64_tr_b16 v[124:125], v213 offset:2304
  ds_read_b64_tr_b16 v[126:127], v209 offset:3072
  ds_read_b64_tr_b16 v[128:129], v213 offset:3328
  s_waitcnt lgkmcnt(4)
  buffer_store_dwordx4 v[106:109], v222, s[36:39], 0 offen offset:0 sc0 sc1
  buffer_store_dwordx4 v[110:113], v222, s[36:39], 0 offen offset:640 sc0 sc1
  s_waitcnt lgkmcnt(0)
  buffer_store_dwordx4 v[122:125], v223, s[36:39], 0 offen offset:0 sc0 sc1
  buffer_store_dwordx4 v[126:129], v223, s[36:39], 0 offen offset:640 sc0 sc1
k1_fin:
  s_branch k2_go
k1_side:
  s_lshl_b32 s57, s45, 2
  s_add_u32 s57, s57, s44
  s_lshl_b32 s49, s57, 12
  s_add_u32 s49, s49, 8126464
  s_lshl_b32 s57, s57, 2
  v_mov_b32 v220, -1
  v_mov_b32 v221, -1
  v_mov_b32 v222, -1
  v_mov_b32 v223, -1
  v_mov_b32 v224, 15
  v_mov_b32 v225, s57
  s_waitcnt lgkmcnt(0)
  s_add_u32 s36, s12, s49
  s_addc_u32 s37, s13, 0
  s_mov_b32 s38, 4096
  s_mov_b32 s39, 0x20000
  s_mov_b32 s40, s10
  s_mov_b32 s41, s11
  s_mov_b32 s42, 256
  s_mov_b32 s43, 0x20000
  buffer_store_dwordx4 v[220:223], v199, s[36:39], 0 offen offset:0 sc0 sc1
  buffer_store_dwordx4 v[220:223], v199, s[36:39], 0 offen offset:1024 sc0 sc1
  buffer_store_dwordx4 v[220:223], v199, s[36:39], 0 offen offset:2048 sc0 sc1
  buffer_store_dwordx4 v[220:223], v199, s[36:39], 0 offen offset:3072 sc0 sc1
  s_lshl_b32 s49, s57, 8
  s_add_u32 s49, s49, 0x11e0000
  v_add_u32 v226, s49, v199
  global_store_dwordx4 v226, v[220:223], s[12:13] sc0 sc1
  s_mul_i32 s55, s44, 10240
  v_add_u32 v216, s55, v199
  s_mul_i32 s45, s45, 3
  s_add_u32 s36, s12, 16777216
  s_addc_u32 s37, s13, 0
  s_mov_b32 s38, 1925120
  s_mov_b32 s39, 0x20000
  s_add_u32 s49, s45, 0
  s_sub_u32 s50, s49, 27
  s_cmp_lt_u32 s49, 27
  s_cselect_b32 s50, s49, s50
  s_cselect_b32 s51, s16, s14
  s_cselect_b32 s52, s17, s15
  s_mul_i32 s50, s50, 40960
  s_add_u32 s24, s51, s50
  s_addc_u32 s25, s52, 0
  s_cmp_lt_u32 s49, 47
  s_cselect_b32 s26, 40960, 0
  s_mov_b32 s27, 0x20000
  s_add_u32 m0, s55, 0
  s_mov_b32 s53, 0
  buffer_load_dwordx4 v216, s[24:27], s53 offen offset:0 lds
  buffer_load_dwordx4 v216, s[24:27], s53 offen offset:1024 lds
  buffer_load_dwordx4 v216, s[24:27], s53 offen offset:2048 lds
  buffer_load_dwordx4 v216, s[24:27], s53 offen offset:3072 lds
  s_add_u32 m0, s55, 4096
  s_mov_b32 s53, 4096
  buffer_load_dwordx4 v216, s[24:27], s53 offen offset:0 lds
  buffer_load_dwordx4 v216, s[24:27], s53 offen offset:1024 lds
  buffer_load_dwordx4 v216, s[24:27], s53 offen offset:2048 lds
  buffer_load_dwordx4 v216, s[24:27], s53 offen offset:3072 lds
  s_add_u32 m0, s55, 8192
  s_mov_b32 s53, 8192
  buffer_load_dwordx4 v216, s[24:27], s53 offen offset:0 lds
  buffer_load_dwordx4 v216, s[24:27], s53 offen offset:1024 lds
  s_waitcnt vmcnt(10)
  buffer_store_dword v224, v225, s[40:43], 0 offen sc0 sc1
  s_add_u32 s49, s45, 1
  s_sub_u32 s50, s49, 27
  s_cmp_lt_u32 s49, 27
  s_cselect_b32 s50, s49, s50
  s_cselect_b32 s51, s16, s14
  s_cselect_b32 s52, s17, s15
  s_mul_i32 s50, s50, 40960
  s_add_u32 s24, s51, s50
  s_addc_u32 s25, s52, 0
  s_cmp_lt_u32 s49, 47
  s_cselect_b32 s26, 40960, 0
  s_mov_b32 s27, 0x20000
  s_add_u32 m0, s55, 40960
  s_mov_b32 s53, 0
  buffer_load_dwordx4 v216, s[24:27], s53 offen offset:0 lds
  buffer_load_dwordx4 v216, s[24:27], s53 offen offset:1024 lds
  buffer_load_dwordx4 v216, s[24:27], s53 offen offset:2048 lds
  buffer_load_dwordx4 v216, s[24:27], s53 offen offset:3072 lds
  s_add_u32 m0, s55, 45056
  s_mov_b32 s53, 4096
  buffer_load_dwordx4 v216, s[24:27], s53 offen offset:0 lds
  buffer_load_dwordx4 v216, s[24:27], s53 offen offset:1024 lds
  buffer_load_dwordx4 v216, s[24:27], s53 offen offset:2048 lds
  buffer_load_dwordx4 v216, s[24:27], s53 offen offset:3072 lds
  s_add_u32 m0, s55, 49152
  s_mov_b32 s53, 8192
  buffer_load_dwordx4 v216, s[24:27], s53 offen offset:0 lds
  buffer_load_dwordx4 v216, s[24:27], s53 offen offset:1024 lds
  s_add_u32 s49, s45, 2
  s_sub_u32 s50, s49, 27
  s_cmp_lt_u32 s49, 27
  s_cselect_b32 s50, s49, s50
  s_cselect_b32 s51, s16, s14
  s_cselect_b32 s52, s17, s15
  s_mul_i32 s50, s50, 40960
  s_add_u32 s24, s51, s50
  s_addc_u32 s25, s52, 0
  s_cmp_lt_u32 s49, 47
  s_cselect_b32 s26, 40960, 0
  s_mov_b32 s27, 0x20000
  s_add_u32 m0, s55, 81920
  s_mov_b32 s53, 0
  buffer_load_dwordx4 v216, s[24:27], s53 offen offset:0 lds
  buffer_load_dwordx4 v216, s[24:27], s53 offen offset:1024 lds
  buffer_load_dwordx4 v216, s[24:27], s53 offen offset:2048 lds
  buffer_load_dwordx4 v216, s[24:27], s53 offen offset:3072 lds
  s_add_u32 m0, s55, 86016
  s_mov_b32 s53, 4096
  buffer_load_dwordx4 v216, s[24:27], s53 offen offset:0 lds
  buffer_load_dwordx4 v216, s[24:27], s53 offen offset:1024 lds
  buffer_load_dwordx4 v216, s[24:27], s53 offen offset:2048 lds
  buffer_load_dwordx4 v216, s[24:27], s53 offen offset:3072 lds
  s_add_u32 m0, s55, 90112
  s_mov_b32 s53, 8192
  buffer_load_dwordx4 v216, s[24:27], s53 offen offset:0 lds
  buffer_load_dwordx4 v216, s[24:27], s53 offen offset:1024 lds
  v_lshrrev_b32 v217, 4, v198
  v_bfe_u32 v218, v198, 2, 2
  v_lshl_add_u32 v217, v217, 3, v218
  v_mul_u32_u24 v217, 1280, v217
  v_and_b32 v218, 3, v198
  v_mul_u32_u24 v218, 40, v218
  s_mul_i32 s49, s44, 320
  v_add3_u32 v217, v217, v218, s49
  s_waitcnt vmcnt(21)
  s_barrier
  ds_read_b64_tr_b16 v[2:3], v217 offset:0
  ds_read_b64_tr_b16 v[4:5], v217 offset:5120
  ds_read_b64_tr_b16 v[6:7], v217 offset:8
  ds_read_b64_tr_b16 v[8:9], v217 offset:5128
  ds_read_b64_tr_b16 v[10:11], v217 offset:16
  ds_read_b64_tr_b16 v[12:13], v217 offset:5136
  ds_read_b64_tr_b16 v[14:15], v217 offset:24
  ds_read_b64_tr_b16 v[16:17], v217 offset:5144
  ds_read_b64_tr_b16 v[18:19], v217 offset:32
  ds_read_b64_tr_b16 v[20:21], v217 offset:5152
  ds_read_b64_tr_b16 v[22:23], v217 offset:160
  ds_read_b64_tr_b16 v[24:25], v217 offset:5280
  ds_read_b64_tr_b16 v[26:27], v217 offset:168
  ds_read_b64_tr_b16 v[28:29], v217 offset:5288
  ds_read_b64_tr_b16 v[30:31], v217 offset:176
  ds_read_b64_tr_b16 v[32:33], v217 offset:5296
  ds_read_b64_tr_b16 v[34:35], v217 offset:184
  ds_read_b64_tr_b16 v[36:37], v217 offset:5304
  ds_read_b64_tr_b16 v[38:39], v217 offset:192
  ds_read_b64_tr_b16 v[40:41], v217 offset:5312
  v_add_u32 v217, 40960, v217
  s_add_u32 s49, s45, 0
  s_cmp_lt_u32 s49, 47
  s_cselect_b32 s38, s38, 0
  s_mul_i32 s50, s44, 94
  s_add_u32 s49, s49, s50
  s_mul_i32 s49, s49, 5120
  s_waitcnt lgkmcnt(0)
  s_add_u32 s50, s49, 0
  buffer_store_dwordx4 v[2:5], v199, s[36:39], s50 offen sc0 sc1
  s_add_u32 s50, s49, 1024
  buffer_store_dwordx4 v[6:9], v199, s[36:39], s50 offen sc0 sc1
  s_add_u32 s50, s49, 2048
  buffer_store_dwordx4 v[10:13], v199, s[36:39], s50 offen sc0 sc1
  s_add_u32 s50, s49, 3072
  buffer_store_dwordx4 v[14:17], v199, s[36:39], s50 offen sc0 sc1
  s_add_u32 s50, s49, 4096
  buffer_store_dwordx4 v[18:21], v199, s[36:39], s50 offen sc0 sc1
  s_add_u32 s50, s49, 240640
  buffer_store_dwordx4 v[22:25], v199, s[36:39], s50 offen sc0 sc1
  s_add_u32 s50, s49, 241664
  buffer_store_dwordx4 v[26:29], v199, s[36:39], s50 offen sc0 sc1
  s_add_u32 s50, s49, 242688
  buffer_store_dwordx4 v[30:33], v199, s[36:39], s50 offen sc0 sc1
  s_add_u32 s50, s49, 243712
  buffer_store_dwordx4 v[34:37], v199, s[36:39], s50 offen sc0 sc1
  s_add_u32 s50, s49, 244736
  buffer_store_dwordx4 v[38:41], v199, s[36:39], s50 offen sc0 sc1
  s_waitcnt vmcnt(20)
  s_barrier
  ds_read_b64_tr_b16 v[42:43], v217 offset:0
  ds_read_b64_tr_b16 v[44:45], v217 offset:5120
  ds_read_b64_tr_b16 v[46:47], v217 offset:8
  ds_read_b64_tr_b16 v[48:49], v217 offset:5128
  ds_read_b64_tr_b16 v[50:51], v217 offset:16
  ds_read_b64_tr_b16 v[52:53], v217 offset:5136
  ds_read_b64_tr_b16 v[54:55], v217 offset:24
  ds_read_b64_tr_b16 v[56:57], v217 offset:5144
  ds_read_b64_tr_b16 v[58:59], v217 offset:32
  ds_read_b64_tr_b16 v[60:61], v217 offset:5152
  ds_read_b64_tr_b16 v[62:63], v217 offset:160
  ds_read_b64_tr_b16 v[64:65], v217 offset:5280
  ds_read_b64_tr_b16 v[66:67], v217 offset:168
  ds_read_b64_tr_b16 v[68:69], v217 offset:5288
  ds_read_b64_tr_b16 v[70:71], v217 offset:176
  ds_read_b64_tr_b16 v[72:73], v217 offset:5296
  ds_read_b64_tr_b16 v[74:75], v217 offset:184
  ds_read_b64_tr_b16 v[76:77], v217 offset:5304
  ds_read_b64_tr_b16 v[78:79], v217 offset:192
  ds_read_b64_tr_b16 v[80:81], v217 offset:5312
  v_add_u32 v217, 40960, v217
  s_add_u32 s49, s45, 1
  s_cmp_lt_u32 s49, 47
  s_cselect_b32 s38, s38, 0
  s_mul_i32 s50, s44, 94
  s_add_u32 s49, s49, s50
  s_mul_i32 s49, s49, 5120
  s_waitcnt lgkmcnt(0)
  s_add_u32 s50, s49, 0
  buffer_store_dwordx4 v[42:45], v199, s[36:39], s50 offen sc0 sc1
  s_add_u32 s50, s49, 1024
  buffer_store_dwordx4 v[46:49], v199, s[36:39], s50 offen sc0 sc1
  s_add_u32 s50, s49, 2048
  buffer_store_dwordx4 v[50:53], v199, s[36:39], s50 offen sc0 sc1
  s_add_u32 s50, s49, 3072
  buffer_store_dwordx4 v[54:57], v199, s[36:39], s50 offen sc0 sc1
  s_add_u32 s50, s49, 4096
  buffer_store_dwordx4 v[58:61], v199, s[36:39], s50 offen sc0 sc1
  s_add_u32 s50, s49, 240640
  buffer_store_dwordx4 v[62:65], v199, s[36:39], s50 offen sc0 sc1
  s_add_u32 s50, s49, 241664
  buffer_store_dwordx4 v[66:69], v199, s[36:39], s50 offen sc0 sc1
  s_add_u32 s50, s49, 242688
  buffer_store_dwordx4 v[70:73], v199, s[36:39], s50 offen sc0 sc1
  s_add_u32 s50, s49, 243712
  buffer_store_dwordx4 v[74:77], v199, s[36:39], s50 offen sc0 sc1
  s_add_u32 s50, s49, 244736
  buffer_store_dwordx4 v[78:81], v199, s[36:39], s50 offen sc0 sc1
  s_waitcnt vmcnt(20)
  s_barrier
  ds_read_b64_tr_b16 v[82:83], v217 offset:0
  ds_read_b64_tr_b16 v[84:85], v217 offset:5120
  ds_read_b64_tr_b16 v[86:87], v217 offset:8
  ds_read_b64_tr_b16 v[88:89], v217 offset:5128
  ds_read_b64_tr_b16 v[90:91], v217 offset:16
  ds_read_b64_tr_b16 v[92:93], v217 offset:5136
  ds_read_b64_tr_b16 v[94:95], v217 offset:24
  ds_read_b64_tr_b16 v[96:97], v217 offset:5144
  ds_read_b64_tr_b16 v[98:99], v217 offset:32
  ds_read_b64_tr_b16 v[100:101], v217 offset:5152
  ds_read_b64_tr_b16 v[102:103], v217 offset:160
  ds_read_b64_tr_b16 v[104:105], v217 offset:5280
  ds_read_b64_tr_b16 v[106:107], v217 offset:168
  ds_read_b64_tr_b16 v[108:109], v217 offset:5288
  ds_read_b64_tr_b16 v[110:111], v217 offset:176
  ds_read_b64_tr_b16 v[112:113], v217 offset:5296
  ds_read_b64_tr_b16 v[114:115], v217 offset:184
  ds_read_b64_tr_b16 v[116:117], v217 offset:5304
  ds_read_b64_tr_b16 v[118:119], v217 offset:192
  ds_read_b64_tr_b16 v[120:121], v217 offset:5312
  v_add_u32 v217, 40960, v217
  s_add_u32 s49, s45, 2
  s_cmp_lt_u32 s49, 47
  s_cselect_b32 s38, s38, 0
  s_mul_i32 s50, s44, 94
  s_add_u32 s49, s49, s50
  s_mul_i32 s49, s49, 5120
  s_waitcnt lgkmcnt(0)
  s_add_u32 s50, s49, 0
  buffer_store_dwordx4 v[82:85], v199, s[36:39], s50 offen sc0 sc1
  s_add_u32 s50, s49, 1024
  buffer_store_dwordx4 v[86:89], v199, s[36:39], s50 offen sc0 sc1
  s_add_u32 s50, s49, 2048
  buffer_store_dwordx4 v[90:93], v199, s[36:39], s50 offen sc0 sc1
  s_add_u32 s50, s49, 3072
  buffer_store_dwordx4 v[94:97], v199, s[36:39], s50 offen sc0 sc1
  s_add_u32 s50, s49, 4096
  buffer_store_dwordx4 v[98:101], v199, s[36:39], s50 offen sc0 sc1
  s_add_u32 s50, s49, 240640
  buffer_store_dwordx4 v[102:105], v199, s[36:39], s50 offen sc0 sc1
  s_add_u32 s50, s49, 241664
  buffer_store_dwordx4 v[106:109], v199, s[36:39], s50 offen sc0 sc1
  s_add_u32 s50, s49, 242688
  buffer_store_dwordx4 v[110:113], v199, s[36:39], s50 offen sc0 sc1
  s_add_u32 s50, s49, 243712
  buffer_store_dwordx4 v[114:117], v199, s[36:39], s50 offen sc0 sc1
  s_add_u32 s50, s49, 244736
  buffer_store_dwordx4 v[118:121], v199, s[36:39], s50 offen sc0 sc1
  v_lshlrev_b32 v210, 2, v198
  v_mov_b32 v226, 0
  s_mov_b32 s59, 0
k1s_c0:
  v_cmp_ne_u32 vcc, 15, v226
  s_nop 1
  s_cbranch_vccz k1s_c1
  s_add_u32 s59, s59, 0x4000
  s_cbranch_scc1 k1s_c1
  buffer_load_dword v226, v210, s[40:43], 0 offen sc1
  s_waitcnt vmcnt(0)
  s_branch k1s_c0
k1s_c1:
  s_branch k2_go
k1_end:
  s_endpgm
k2_go:
  s_getpc_b64 s[96:97]
k2_pc:
  s_load_dwordx2 s[14:15], s[0:1], 40
  s_load_dwordx2 s[16:17], s[0:1], 48
  s_load_dwordx2 s[4:5], s[0:1], 80
  s_load_dwordx2 s[6:7], s[0:1], 0
  s_load_dwordx2 s[8:9], s[0:1], 64
  v_lshrrev_b32 v208, 6, v0
  v_and_b32 v203, 63, v0
  v_readfirstlane_b32 s10, v208
  s_and_b32 s47, s2, 7
  s_lshr_b32 s48, s2, 6
  s_lshl_b32 s47, s47, 2
  s_add_u32 s11, s47, s48
  s_bfe_u32 s12, s2, 0x30003
  s_lshl_b32 s44, s12, 2
  s_add_u32 s44, s44, s10
  s_and_b32 s45, s11, 1
  s_lshr_b32 s46, s11, 1
  s_mul_i32 s46, s46, 2560
  s_mov_b32 s57, 0
  v_and_b32 v204, 31, v0
  v_bfe_u32 v205, v0, 5, 1
  v_mov_b32 v202, 0xdddddddd
  s_cmp_lt_u32 s12, 7
  s_cselect_b32 s58, 262144, 0
  s_cmp_lt_u32 s44, 27
  s_cselect_b32 s59, 0x20000, 0
  s_cselect_b32 s60, 16777216, 0
  s_lshl_b32 s54, s10, 12
  s_mul_i32 s55, s10, 3072
  s_add_u32 s55, s55, 65536
  s_mov_b32 s53, 5120
  s_cmp_lt_u32 s10, 2
  s_cselect_b32 s53, 327680, s53
  s_lshl_b32 s47, s11, 18
  s_lshl_b32 s48, s44, 17
  s_add_u32 s48, s48, 12648448
  s_waitcnt lgkmcnt(0)
  s_add_u32 s20, s14, s47
  s_addc_u32 s21, s15, 0
  s_mov_b32 s22, s58
  s_mov_b32 s23, 0x20000
  s_mov_b32 s24, s4
  s_mov_b32 s25, s5
  s_mov_b32 s26, 8388608
  s_mov_b32 s27, 0x20000
  s_add_u32 s28, s4, s48
  s_addc_u32 s29, s5, 0
  s_mov_b32 s30, s59
  s_mov_b32 s31, 0x20000
  s_mov_b32 s32, s4
  s_mov_b32 s33, s5
  s_mov_b32 s34, s60
  s_mov_b32 s35, 0x20000
  s_mov_b32 s36, s4
  s_mov_b32 s37, s5
  s_mov_b32 s38, 5505024
  s_mov_b32 s39, 0x20000
  s_lshr_b32 s47, s2, 2
  s_lshl_b32 s47, s47, 5
  s_and_b32 s48, s2, 3
  s_add_u32 s47, s47, s48
  s_lshl_b32 s47, s47, 2
  s_add_u32 s47, s47, 18776064
  v_mov_b32 v209, s47
  v_mov_b32 v210, 1
  s_waitcnt vmcnt(0)
  s_barrier
  s_cmp_lg_u32 s10, 0
  s_cbranch_scc1 k2_ng
  s_mov_b64 exec, 1
  global_store_dword v209, v210, s[4:5] sc0 sc1
  s_mov_b64 exec, -1
k2_ng:
  s_lshl_b32 s47, s12, 2
  s_add_u32 s47, s47, s10
  s_mul_i32 s48, s47, 163840
  s_add_u32 s48, s48, s46
  s_mul_i32 s49, s45, 1536
  s_add_u32 s49, s49, s48
  v_lshlrev_b32 v196, 4, v203
  v_add_u32 v197, s49, v196
  s_lshl_b32 s49, s45, 3
  s_add_u32 s49, s49, s48
  s_add_u32 s49, s49, 1024
  v_add_u32 v198, s49, v196
  v_mov_b32 v208, 2146435072
  v_cmp_gt_u32 vcc, 32, v203
  s_mov_b32 s49, 81920
  s_nop 0
  v_cndmask_b32 v198, v208, v198, vcc
k2_restart:
  s_mul_i32 s47, s10, 163840
  s_add_u32 s47, s47, s46
  s_lshl_b32 s48, s45, 10
  s_add_u32 s47, s47, s48
  s_add_u32 s47, s47, 40960
  s_mul_i32 s48, s11, 81920
  s_mul_i32 s49, s10, 3072
  s_add_u32 s48, s48, s49
  s_add_u32 s48, s48, 5498880
  s_cmp_lt_u32 s10, 2
  s_cselect_b32 s47, s47, s48
  s_cselect_b32 s48, 80384, 0
  s_cmp_eq_u32 s10, 3
  s_cselect_b32 s49, 2146435072, s48
  v_add_u32 v193, s47, v196
  v_mul_lo_u32 v208, v205, s48
  v_add_u32 v195, s49, v193
  v_add_u32 v194, v208, v193
  v_lshrrev_b32 v208, 4, v203
  v_and_b32 v209, 15, v203
  s_lshl_b32 s47, s10, 16
  v_add_u32 v210, 0, v208
  v_xor_b32 v211, v209, v210
  v_lshlrev_b32 v210, 12, v210
  v_lshl_add_u32 v210, v211, 4, v210
  v_add_u32 v189, s47, v210
  v_add_u32 v210, 4, v208
  v_xor_b32 v211, v209, v210
  v_lshlrev_b32 v210, 12, v210
  v_lshl_add_u32 v210, v211, 4, v210
  v_add_u32 v190, s47, v210
  v_subrev_u32 v190, 1024, v190
  v_add_u32 v210, 8, v208
  v_xor_b32 v211, v209, v210
  v_lshlrev_b32 v210, 12, v210
  v_lshl_add_u32 v210, v211, 4, v210
  v_add_u32 v191, s47, v210
  v_subrev_u32 v191, 2048, v191
  v_add_u32 v210, 12, v208
  v_xor_b32 v211, v209, v210
  v_lshlrev_b32 v210, 12, v210
  v_lshl_add_u32 v210, v211, 4, v210
  v_add_u32 v192, s47, v210
  v_subrev_u32 v192, 3072, v192
  s_and_b32 s50, s2, 0
  s_lshl_b32 s52, s50, 14
  s_lshl_b32 s50, s50, 9
  s_movk_i32 s58, 256
  s_mov_b32 s51, 0
  s_mov_b32 s56, 0
  s_mov_b32 s40, s16
  s_mov_b32 s41, s17
  s_mov_b32 s42, 4096
  s_mov_b32 s43, 0x20000
  s_mov_b32 m0, s54
  s_lshl_b32 s47, s11, 7
  v_lshl_add_u32 v208, v204, 1, s47
  buffer_load_dwordx4 v189, s[20:23], s50 offen offset:0 sc1 lds
  buffer_load_dwordx4 v190, s[20:23], s50 offen offset:1024 sc1 lds
  buffer_load_dwordx4 v191, s[20:23], s50 offen offset:2048 sc1 lds
  buffer_load_dwordx4 v192, s[20:23], s50 offen offset:3072 sc1 lds
  buffer_load_ushort v170, v208, s[40:43], 0 offen offset:0
  buffer_load_ushort v171, v208, s[40:43], 0 offen offset:64
  s_add_u32 m0, s54, 16384
  s_add_u32 s50, s50, 256
  buffer_load_dwordx4 v189, s[20:23], s50 offen offset:0 sc1 lds
  buffer_load_dwordx4 v190, s[20:23], s50 offen offset:1024 sc1 lds
  buffer_load_dwordx4 v191, s[20:23], s50 offen offset:2048 sc1 lds
  buffer_load_dwordx4 v192, s[20:23], s50 offen offset:3072 sc1 lds
  s_add_u32 m0, s54, 32768
  s_add_u32 s50, s50, 256
  s_bitset0_b32 s50, 12
  buffer_load_dwordx4 v189, s[20:23], s50 offen offset:0 sc1 lds
  buffer_load_dwordx4 v190, s[20:23], s50 offen offset:1024 sc1 lds
  s_mul_i32 s47, s11, 81920
  v_mov_b32 v254, s47
  global_load_dword v255, v254, s[6:7]
  global_load_dword v255, v254, s[8:9]
  s_mul_i32 s47, s11, 110592
  s_lshl_b32 s48, s44, 11
  s_add_u32 s47, s47, s48
  v_add_u32 v199, s47, v196
  s_mov_b32 s18, 8388608
  s_mov_b32 s19, 8443904
  v_and_b32 v209, 15, v203
  v_lshlrev_b32 v210, 8, v204
  v_add_u32 v208, 0, v205
  v_xor_b32 v208, v208, v209
  v_lshl_add_u32 v172, v208, 4, v210
  v_add_u32 v208, 2, v205
  v_xor_b32 v208, v208, v209
  v_lshl_add_u32 v173, v208, 4, v210
  v_add_u32 v208, 4, v205
  v_xor_b32 v208, v208, v209
  v_lshl_add_u32 v174, v208, 4, v210
  v_add_u32 v208, 6, v205
  v_xor_b32 v208, v208, v209
  v_lshl_add_u32 v175, v208, 4, v210
  v_add_u32 v208, 8, v205
  v_xor_b32 v208, v208, v209
  v_lshl_add_u32 v176, v208, 4, v210
  v_add_u32 v208, 10, v205
  v_xor_b32 v208, v208, v209
  v_lshl_add_u32 v177, v208, 4, v210
  v_add_u32 v208, 12, v205
  v_xor_b32 v208, v208, v209
  v_lshl_add_u32 v178, v208, 4, v210
  v_add_u32 v208, 14, v205
  v_xor_b32 v208, v208, v209
  v_lshl_add_u32 v179, v208, 4, v210
  s_lshl_b32 s47, s45, 9
  s_add_u32 s47, s47, 65536
  v_add_u32 v180, s47, v196
  s_cmp_eq_u32 s45, 0
  s_cselect_b32 s47, 1024, 8
  s_cselect_b32 s48, 0, 4
  s_cselect_b32 s49, 0, 16
  s_add_u32 s47, s47, 65536
  v_cmp_gt_u32 vcc, 32, v203
  v_mov_b32 v212, 114688
  v_add_u32 v208, s47, v196
  v_cndmask_b32 v181, v212, v208, vcc
  v_add_u32 v208, 12288, v208
  v_cndmask_b32 v182, v212, v208, vcc
  v_add_u32 v208, 12288, v208
  v_cndmask_b32 v183, v212, v208, vcc
  v_add_u32 v208, 12288, v208
  v_cndmask_b32 v184, v212, v208, vcc
  v_and_b32 v208, 3, v204
  v_bfe_u32 v209, v204, 2, 1
  v_bfe_u32 v210, v204, 3, 1
  v_lshl_add_u32 v208, v209, 3, v208
  v_lshl_add_u32 v208, v210, 2, v208
  v_add_u32 v208, s48, v208
  v_subrev_u32 v209, s49, v204
  v_cmp_gt_u32 vcc, 16, v204
  v_mul_u32_u24 v210, 320, v205
  v_add_u32 v210, 71680, v210
  v_cndmask_b32 v208, v209, v208, vcc
  v_cmp_gt_u32 vcc, 20, v204
  v_lshl_add_u32 v208, v208, 4, v210
  s_nop 0
  v_cndmask_b32 v185, v212, v208, vcc
  v_add_u32 v208, 12288, v208
  v_cndmask_b32 v186, v212, v208, vcc
  v_add_u32 v208, 12288, v208
  v_cndmask_b32 v187, v212, v208, vcc
  v_add_u32 v208, 12288, v208
  v_cndmask_b32 v188, v212, v208, vcc
  v_mov_b32 v208, 1065369472
  v_mov_b32 v209, 1065369472
  v_mov_b32 v210, 1065369472
  v_mov_b32 v211, 1065369472
  v_lshl_add_u32 v212, v0, 4, v212
  v_mov_b32 v213, 119808
  v_mov_b32 v214, 0
  ds_write_b128 v212, v[208:211]
  ds_write_b128 v212, v[208:211] offset:1024
  ds_write_b32 v213, v214
  v_mov_b32 v34, 0
  v_mov_b32 v35, 0
  v_mov_b32 v36, 0
  v_mov_b32 v37, 0
  v_mov_b32 v38, 0
  v_mov_b32 v39, 0
  v_mov_b32 v40, 0
  v_mov_b32 v41, 0
  v_mov_b32 v42, 0
  v_mov_b32 v43, 0
  v_mov_b32 v44, 0
  v_mov_b32 v45, 0
  v_mov_b32 v46, 0
  v_mov_b32 v47, 0
  v_mov_b32 v48, 0
  v_mov_b32 v49, 0
  v_mov_b32 v50, 0
  v_mov_b32 v51, 0
  v_mov_b32 v52, 0
  v_mov_b32 v53, 0
  v_mov_b32 v54, 0
  v_mov_b32 v55, 0
  v_mov_b32 v56, 0
  v_mov_b32 v57, 0
  v_mov_b32 v58, 0
  v_mov_b32 v59, 0
  v_mov_b32 v60, 0
  v_mov_b32 v61, 0
  v_mov_b32 v62, 0
  v_mov_b32 v63, 0
  v_mov_b32 v64, 0
  v_mov_b32 v65, 0
  v_mov_b32 v26, 0
  v_mov_b32 v27, 0
  v_mov_b32 v28, 0
  v_mov_b32 v29, 0
  v_mov_b32 v30, 0
  v_mov_b32 v31, 0
  v_mov_b32 v32, 0
  v_mov_b32 v33, 0
  v_mov_b32 v134, 0
  v_mov_b32 v135, 0
  v_mov_b32 v136, 0
  v_mov_b32 v137, 0
  v_mov_b32 v150, 0
  v_mov_b32 v151, 0
  v_mov_b32 v152, 0
  v_mov_b32 v153, 0
  v_accvgpr_write_b32 a60, 0
  v_accvgpr_write_b32 a61, 0
  v_accvgpr_write_b32 a62, 0
  v_accvgpr_write_b32 a63, 0
  s_mul_i32 s47, s12, 240640
  s_add_u32 s47, s47, 16777216
  v_lshlrev_b32 v216, 4, v0
  s_lshl_b32 s62, s10, 10
  s_mov_b32 s61, 126976
  s_add_u32 s40, s4, s47
  s_addc_u32 s41, s5, 0
  s_mov_b32 s42, 240640
  s_mov_b32 s43, 0x20000
  v_lshlrev_b32 v212, 7, v203
  v_add_u32 v212, 18776064, v212
  s_mov_b32 s49, 0
  s_cmp_lg_u32 s10, 0
  s_cbranch_scc1 k2_g1
k2_g0:
  global_load_dwordx4 v[208:211], v212, s[4:5] sc1
  s_add_u32 s49, s49, 0x2000
  s_cbranch_scc1 k2_g1
  s_waitcnt vmcnt(0)
  v_or3_b32 v208, v208, v209, v210
  v_or_b32 v208, v208, v211
  v_cmp_ne_u32 vcc, 1, v208
  s_nop 1
  s_cbranch_vccnz k2_g0
k2_g1:
  s_waitcnt vmcnt(0) lgkmcnt(0)
  s_barrier
  s_mov_b32 m0, s55
  s_mov_b32 s49, 81920
  s_cmp_lg_u32 s57, 0
  s_cbranch_scc1 k2_nq
  buffer_load_dwordx4 v[98:101], v197, s[24:27], 0 offen sc1
  buffer_load_dwordx2 v[106:107], v198, s[24:27], 0 offen sc1
  buffer_load_dwordx4 v[102:105], v197, s[24:27], s49 offen sc1
  buffer_load_dwordx2 v[108:109], v198, s[24:27], s49 offen sc1
k2_nq:
  buffer_load_dwordx4 v193, s[24:27], s51 offen offset:0 sc1 lds
  buffer_load_dwordx4 v194, s[24:27], s51 offen offset:1024 sc1 lds
  buffer_load_dwordx4 v195, s[24:27], s51 offen offset:2048 sc1 lds
  buffer_load_dwordx4 a[0:3], v196, s[28:31], s52 offen offset:0 sc1
  buffer_load_dwordx4 a[4:7], v196, s[28:31], s52 offen offset:1024 sc1
  s_add_u32 s51, s51, s53
  s_add_u32 m0, s55, 12288
  s_nop 0
  buffer_load_dwordx4 v193, s[24:27], s51 offen offset:0 sc1 lds
  buffer_load_dwordx4 v194, s[24:27], s51 offen offset:1024 sc1 lds
  buffer_load_dwordx4 v195, s[24:27], s51 offen offset:2048 sc1 lds
  s_add_u32 m0, s54, 32768
  buffer_load_dwordx4 a[8:11], v196, s[28:31], s52 offen offset:2048 sc1
  v_lshlrev_b32 v66, 16, v170
  v_mov_b32 v67, v66
  v_mov_b32 v68, v66
  v_mov_b32 v69, v66
  v_mov_b32 v70, v66
  v_mov_b32 v71, v66
  v_mov_b32 v72, v66
  v_mov_b32 v73, v66
  buffer_load_dwordx4 a[12:15], v196, s[28:31], s52 offen offset:3072 sc1
  v_mov_b32 v74, v66
  v_mov_b32 v75, v66
  v_mov_b32 v76, v66
  v_mov_b32 v77, v66
  v_mov_b32 v78, v66
  v_mov_b32 v79, v66
  v_mov_b32 v80, v66
  v_mov_b32 v81, v66
  s_add_u32 s52, s52, 4096
  buffer_load_dwordx4 a[16:19], v196, s[28:31], s52 offen offset:0 sc1
  v_lshlrev_b32 v82, 16, v171
  v_mov_b32 v83, v82
  v_mov_b32 v84, v82
  v_mov_b32 v85, v82
  v_mov_b32 v86, v82
  v_mov_b32 v87, v82
  v_mov_b32 v88, v82
  v_mov_b32 v89, v82
  buffer_load_dwordx4 a[20:23], v196, s[28:31], s52 offen offset:1024 sc1
  v_mov_b32 v90, v82
  v_mov_b32 v91, v82
  v_mov_b32 v92, v82
  v_mov_b32 v93, v82
  v_mov_b32 v94, v82
  v_mov_b32 v95, v82
  v_mov_b32 v96, v82
  v_mov_b32 v97, v82
  buffer_load_dwordx4 a[24:27], v196, s[28:31], s52 offen offset:2048 sc1
  s_waitcnt vmcnt(10)
  s_barrier
  ds_read_b128 v[110:113], v180 offset:0
  ds_read_b64 v[118:119], v181 offset:0
  ds_read_b128 v[138:141], v172 offset:0
  ds_read_b128 v[122:125], v185 offset:0
  ds_read_b128 v[130:133], v185 offset:640
  buffer_load_dwordx4 a[28:31], v196, s[28:31], s52 offen offset:3072 sc1
  s_add_u32 s52, s52, 4096
  buffer_load_dwordx4 a[32:35], v196, s[28:31], s52 offen offset:0 sc1
  buffer_load_dwordx4 a[36:39], v196, s[28:31], s52 offen offset:1024 sc1
  s_waitcnt lgkmcnt(3)
  v_mfma_f32_32x32x16_bf16 v[2:17], v[110:113], v[98:101], 0
  s_nop 1
  v_mfma_f32_32x32x8_bf16 v[2:17], v[118:119], v[106:107], v[2:17]
  buffer_load_dwordx4 a[40:43], v196, s[28:31], s52 offen offset:2048 sc1
  buffer_load_dwordx4 a[44:47], v196, s[28:31], s52 offen offset:3072 sc1
  s_nop 7
  s_nop 3
k2_loop:
  v_mfma_f32_32x32x16_bf16 v[82:97], a[60:63], v[150:153], v[82:97]
  s_add_u32 s52, s52, 4096
  ds_read_b128 v[146:149], v172 offset:8192
  v_exp_f32 v2, v2
  v_exp_f32 v3, v3
  v_exp_f32 v4, v4
  v_smfmac_f32_32x32x32_bf16 v[50:65], v[134:137], v[26:33], v202
  s_cmp_eq_u32 s56, 3
  buffer_load_dwordx4 a[48:51], v196, s[28:31], s52 offen offset:0 sc1
  v_exp_f32 v5, v5
  v_exp_f32 v6, v6
  v_mfma_f32_32x32x16_bf16 v[18:33], v[110:113], v[102:105], 0
  s_waitcnt vmcnt(15) lgkmcnt(1)
  ds_read_b128 v[114:117], v180 offset:1536
  ds_read_b64 v[120:121], v181 offset:1536
  v_exp_f32 v7, v7
  v_exp_f32 v8, v8
  v_mfma_f32_32x32x16_bf16 v[66:81], a[0:3], v[138:141], v[66:81]
  s_waitcnt lgkmcnt(4)
  s_cselect_b32 s34, s60, 0
  ds_read_b128 v[142:145], v173 offset:0
  v_exp_f32 v9, v9
  v_exp_f32 v10, v10
  v_exp_f32 v11, v11
  v_mfma_f32_32x32x8_bf16 v[18:33], v[118:119], v[108:109], v[18:33]
  v_exp_f32 v12, v12
  v_exp_f32 v13, v13
  v_exp_f32 v14, v14
  v_exp_f32 v15, v15
  v_smfmac_f32_32x32x32_bf16 v[34:49], v[122:125], v[2:9], v202
  s_waitcnt lgkmcnt(3)
  buffer_load_dwordx4 v191, s[20:23], s50 offen offset:2048 sc1 lds
  v_exp_f32 v16, v16
  v_exp_f32 v17, v17
  v_mfma_f32_32x32x16_bf16 v[82:97], a[0:3], v[146:149], v[82:97]
  ds_read_b128 v[150:153], v173 offset:8192
  v_exp_f32 v18, v18
  v_exp_f32 v19, v19
  v_exp_f32 v20, v20
  v_smfmac_f32_32x32x32_bf16 v[34:49], v[130:133], v[10:17], v202
  s_waitcnt lgkmcnt(3)
  buffer_load_dwordx4 a[52:55], v196, s[28:31], s52 offen offset:1024 sc1
  v_exp_f32 v21, v21
  v_exp_f32 v22, v22
  v_mfma_f32_32x32x16_bf16 v[2:17], v[114:117], v[98:101], 0
  s_waitcnt vmcnt(16) lgkmcnt(1)
  ds_read_b128 v[126:129], v185 offset:1280
  ds_read_b128 v[134:137], v185 offset:1920
  v_exp_f32 v23, v23
  v_exp_f32 v24, v24
  v_mfma_f32_32x32x16_bf16 v[66:81], a[4:7], v[142:145], v[66:81]
  ds_read_b128 v[138:141], v174 offset:0
  v_exp_f32 v25, v25
  v_exp_f32 v26, v26
  v_exp_f32 v27, v27
  v_mfma_f32_32x32x8_bf16 v[2:17], v[120:121], v[106:107], v[2:17]
  v_exp_f32 v28, v28
  v_exp_f32 v29, v29
  v_exp_f32 v30, v30
  v_exp_f32 v31, v31
  v_smfmac_f32_32x32x32_bf16 v[50:65], v[122:125], v[18:25], v202
  s_waitcnt lgkmcnt(3)
  buffer_load_dwordx4 v192, s[20:23], s50 offen offset:3072 sc1 lds
  v_exp_f32 v32, v32
  v_exp_f32 v33, v33
  v_mfma_f32_32x32x16_bf16 v[82:97], a[4:7], v[150:153], v[82:97]
  ds_read_b128 v[146:149], v174 offset:8192
  v_exp_f32 v2, v2
  v_exp_f32 v3, v3
  v_exp_f32 v4, v4
  v_smfmac_f32_32x32x32_bf16 v[50:65], v[130:133], v[26:33], v202
  s_add_u32 s51, s51, s53
  buffer_load_dwordx4 a[56:59], v196, s[28:31], s52 offen offset:2048 sc1
  v_exp_f32 v5, v5
  v_exp_f32 v6, v6
  v_mfma_f32_32x32x16_bf16 v[18:33], v[114:117], v[102:105], 0
  s_waitcnt vmcnt(14) lgkmcnt(1)
  ds_read_b128 v[110:113], v180 offset:3072
  ds_read_b64 v[118:119], v181 offset:3072
  v_exp_f32 v7, v7
  v_exp_f32 v8, v8
  v_mfma_f32_32x32x16_bf16 v[66:81], a[8:11], v[138:141], v[66:81]
  s_add_u32 m0, s55, 24576
  ds_read_b128 v[142:145], v175 offset:0
  v_exp_f32 v9, v9
  v_exp_f32 v10, v10
  v_exp_f32 v11, v11
  v_mfma_f32_32x32x8_bf16 v[18:33], v[120:121], v[108:109], v[18:33]
  v_exp_f32 v12, v12
  v_exp_f32 v13, v13
  v_exp_f32 v14, v14
  v_exp_f32 v15, v15
  v_smfmac_f32_32x32x32_bf16 v[34:49], v[126:129], v[2:9], v202
  s_waitcnt lgkmcnt(3)
  buffer_load_dwordx4 v193, s[24:27], s51 offen offset:0 sc1 lds
  v_exp_f32 v16, v16
  v_exp_f32 v17, v17
  v_mfma_f32_32x32x16_bf16 v[82:97], a[8:11], v[146:149], v[82:97]
  ds_read_b128 v[150:153], v175 offset:8192
  v_exp_f32 v18, v18
  v_exp_f32 v19, v19
  v_exp_f32 v20, v20
  v_smfmac_f32_32x32x32_bf16 v[34:49], v[134:137], v[10:17], v202
  s_waitcnt lgkmcnt(3)
  buffer_load_dwordx4 a[60:63], v196, s[28:31], s52 offen offset:3072 sc1
  v_exp_f32 v21, v21
  v_exp_f32 v22, v22
  v_mfma_f32_32x32x16_bf16 v[2:17], v[110:113], v[98:101], 0
  s_waitcnt vmcnt(15) lgkmcnt(1)
  ds_read_b128 v[122:125], v185 offset:2560
  ds_read_b128 v[130:133], v185 offset:3200
  v_exp_f32 v23, v23
  v_exp_f32 v24, v24
  v_mfma_f32_32x32x16_bf16 v[66:81], a[12:15], v[142:145], v[66:81]
  ds_read_b128 v[138:141], v176 offset:0
  v_exp_f32 v25, v25
  v_exp_f32 v26, v26
  v_exp_f32 v27, v27
  v_mfma_f32_32x32x8_bf16 v[2:17], v[118:119], v[106:107], v[2:17]
  v_exp_f32 v28, v28
  v_exp_f32 v29, v29
  v_exp_f32 v30, v30
  v_exp_f32 v31, v31
  v_smfmac_f32_32x32x32_bf16 v[50:65], v[126:129], v[18:25], v202
  s_waitcnt lgkmcnt(3)
  buffer_load_dwordx4 v194, s[24:27], s51 offen offset:1024 sc1 lds
  v_exp_f32 v32, v32
  v_exp_f32 v33, v33
  v_mfma_f32_32x32x16_bf16 v[82:97], a[12:15], v[150:153], v[82:97]
  s_add_u32 s52, s52, 4096
  ds_read_b128 v[146:149], v176 offset:8192
  v_exp_f32 v2, v2
  v_exp_f32 v3, v3
  v_exp_f32 v4, v4
  v_smfmac_f32_32x32x32_bf16 v[50:65], v[134:137], v[26:33], v202
  buffer_load_dwordx4 a[0:3], v196, s[28:31], s52 offen offset:0 sc1
  v_exp_f32 v5, v5
  v_exp_f32 v6, v6
  v_mfma_f32_32x32x16_bf16 v[18:33], v[110:113], v[102:105], 0
  s_waitcnt vmcnt(16) lgkmcnt(1)
  ds_read_b128 v[114:117], v180 offset:4608
  ds_read_b64 v[120:121], v181 offset:4608
  v_exp_f32 v7, v7
  v_exp_f32 v8, v8
  v_mfma_f32_32x32x16_bf16 v[66:81], a[16:19], v[138:141], v[66:81]
  ds_read_b128 v[142:145], v177 offset:0
  v_exp_f32 v9, v9
  v_exp_f32 v10, v10
  v_exp_f32 v11, v11
  v_mfma_f32_32x32x8_bf16 v[18:33], v[118:119], v[108:109], v[18:33]
  v_exp_f32 v12, v12
  v_exp_f32 v13, v13
  v_exp_f32 v14, v14
  v_exp_f32 v15, v15
  v_smfmac_f32_32x32x32_bf16 v[34:49], v[122:125], v[2:9], v202
  s_waitcnt lgkmcnt(3)
  buffer_load_dwordx4 v195, s[24:27], s51 offen offset:2048 sc1 lds
  v_exp_f32 v16, v16
  v_exp_f32 v17, v17
  v_mfma_f32_32x32x16_bf16 v[82:97], a[16:19], v[146:149], v[82:97]
  s_add_u32 s50, s50, s58
  ds_read_b128 v[150:153], v177 offset:8192
  v_exp_f32 v18, v18
  v_exp_f32 v19, v19
  v_exp_f32 v20, v20
  v_smfmac_f32_32x32x32_bf16 v[34:49], v[130:133], v[10:17], v202
  s_waitcnt lgkmcnt(3)
  buffer_load_dwordx4 a[4:7], v196, s[28:31], s52 offen offset:1024 sc1
  v_exp_f32 v21, v21
  v_exp_f32 v22, v22
  v_mfma_f32_32x32x16_bf16 v[2:17], v[114:117], v[98:101], 0
  s_waitcnt vmcnt(17) lgkmcnt(1)
  ds_read_b128 v[126:129], v185 offset:3840
  ds_read_b128 v[134:137], v185 offset:4480
  v_exp_f32 v23, v23
  v_exp_f32 v24, v24
  v_mfma_f32_32x32x16_bf16 v[66:81], a[20:23], v[142:145], v[66:81]
  ds_read_b128 v[138:141], v178 offset:0
  v_exp_f32 v25, v25
  v_exp_f32 v26, v26
  v_exp_f32 v27, v27
  v_mfma_f32_32x32x8_bf16 v[2:17], v[120:121], v[106:107], v[2:17]
  v_exp_f32 v28, v28
  v_exp_f32 v29, v29
  v_exp_f32 v30, v30
  v_exp_f32 v31, v31
  v_smfmac_f32_32x32x32_bf16 v[50:65], v[122:125], v[18:25], v202
  s_waitcnt lgkmcnt(3)
  buffer_load_dwordx4 v[154:157], v199, s[32:35], s18 offen offset:0 sc1
  buffer_load_dwordx4 v[158:161], v199, s[32:35], s18 offen offset:1024 sc1
  v_exp_f32 v32, v32
  v_exp_f32 v33, v33
  v_mfma_f32_32x32x16_bf16 v[82:97], a[20:23], v[150:153], v[82:97]
  ds_read_b128 v[146:149], v178 offset:8192
  v_exp_f32 v2, v2
  v_exp_f32 v3, v3
  v_exp_f32 v4, v4
  v_smfmac_f32_32x32x32_bf16 v[50:65], v[130:133], v[26:33], v202
  s_waitcnt vmcnt(19)
  s_barrier
  buffer_load_dwordx4 a[8:11], v196, s[28:31], s52 offen offset:2048 sc1
  v_exp_f32 v5, v5
  v_exp_f32 v6, v6
  v_mfma_f32_32x32x16_bf16 v[18:33], v[114:117], v[102:105], 0
  s_waitcnt vmcnt(19) lgkmcnt(1)
  ds_read_b128 v[110:113], v180 offset:12288
  ds_read_b64 v[118:119], v182 offset:0
  v_exp_f32 v7, v7
  v_exp_f32 v8, v8
  v_mfma_f32_32x32x16_bf16 v[66:81], a[24:27], v[138:141], v[66:81]
  s_add_u32 m0, s54, 49152
  ds_read_b128 v[142:145], v179 offset:0
  v_exp_f32 v9, v9
  v_exp_f32 v10, v10
  v_exp_f32 v11, v11
  v_mfma_f32_32x32x8_bf16 v[18:33], v[120:121], v[108:109], v[18:33]
  v_exp_f32 v12, v12
  v_exp_f32 v13, v13
  v_exp_f32 v14, v14
  v_exp_f32 v15, v15
  v_smfmac_f32_32x32x32_bf16 v[34:49], v[126:129], v[2:9], v202
  s_waitcnt lgkmcnt(3)
  buffer_load_dwordx4 v189, s[20:23], s50 offen offset:0 sc1 lds
  v_exp_f32 v16, v16
  v_exp_f32 v17, v17
  v_mfma_f32_32x32x16_bf16 v[82:97], a[24:27], v[146:149], v[82:97]
  ds_read_b128 v[150:153], v179 offset:8192
  v_exp_f32 v18, v18
  v_exp_f32 v19, v19
  v_exp_f32 v20, v20
  v_smfmac_f32_32x32x32_bf16 v[34:49], v[134:137], v[10:17], v202
  s_waitcnt lgkmcnt(3)
  buffer_load_dwordx4 a[12:15], v196, s[28:31], s52 offen offset:3072 sc1
  v_exp_f32 v21, v21
  v_exp_f32 v22, v22
  v_mfma_f32_32x32x16_bf16 v[2:17], v[110:113], v[98:101], 0
  s_waitcnt vmcnt(20) lgkmcnt(1)
  ds_read_b128 v[122:125], v186 offset:0
  ds_read_b128 v[130:133], v186 offset:640
  v_exp_f32 v23, v23
  v_exp_f32 v24, v24
  v_mfma_f32_32x32x16_bf16 v[66:81], a[28:31], v[142:145], v[66:81]
  ds_read_b128 v[138:141], v172 offset:16384
  v_exp_f32 v25, v25
  v_exp_f32 v26, v26
  v_exp_f32 v27, v27
  v_mfma_f32_32x32x8_bf16 v[2:17], v[118:119], v[106:107], v[2:17]
  v_exp_f32 v28, v28
  v_exp_f32 v29, v29
  v_exp_f32 v30, v30
  v_exp_f32 v31, v31
  v_smfmac_f32_32x32x32_bf16 v[50:65], v[126:129], v[18:25], v202
  s_waitcnt lgkmcnt(3)
  buffer_load_dwordx4 v190, s[20:23], s50 offen offset:1024 sc1 lds
  v_exp_f32 v32, v32
  v_exp_f32 v33, v33
  v_mfma_f32_32x32x16_bf16 v[82:97], a[28:31], v[150:153], v[82:97]
  s_add_u32 s52, s52, 4096
  ds_read_b128 v[146:149], v172 offset:24576
  v_exp_f32 v2, v2
  v_exp_f32 v3, v3
  v_exp_f32 v4, v4
  v_smfmac_f32_32x32x32_bf16 v[50:65], v[134:137], v[26:33], v202
  buffer_load_dwordx4 a[16:19], v196, s[28:31], s52 offen offset:0 sc1
  v_exp_f32 v5, v5
  v_exp_f32 v6, v6
  v_mfma_f32_32x32x16_bf16 v[18:33], v[110:113], v[102:105], 0
  s_waitcnt vmcnt(21) lgkmcnt(1)
  ds_read_b128 v[114:117], v180 offset:13824
  ds_read_b64 v[120:121], v182 offset:1536
  v_exp_f32 v7, v7
  v_exp_f32 v8, v8
  v_mfma_f32_32x32x16_bf16 v[66:81], a[32:35], v[138:141], v[66:81]
  ds_read_b128 v[142:145], v173 offset:16384
  v_exp_f32 v9, v9
  v_exp_f32 v10, v10
  v_exp_f32 v11, v11
  v_mfma_f32_32x32x8_bf16 v[18:33], v[118:119], v[108:109], v[18:33]
  v_exp_f32 v12, v12
  v_exp_f32 v13, v13
  v_exp_f32 v14, v14
  v_exp_f32 v15, v15
  v_smfmac_f32_32x32x32_bf16 v[34:49], v[122:125], v[2:9], v202
  s_waitcnt lgkmcnt(3)
  buffer_load_dwordx4 v191, s[20:23], s50 offen offset:2048 sc1 lds
  v_exp_f32 v16, v16
  v_exp_f32 v17, v17
  v_mfma_f32_32x32x16_bf16 v[82:97], a[32:35], v[146:149], v[82:97]
  ds_read_b128 v[150:153], v173 offset:24576
  v_exp_f32 v18, v18
  v_exp_f32 v19, v19
  v_exp_f32 v20, v20
  v_smfmac_f32_32x32x32_bf16 v[34:49], v[130:133], v[10:17], v202
  s_waitcnt lgkmcnt(3)
  buffer_load_dwordx4 a[20:23], v196, s[28:31], s52 offen offset:1024 sc1
  v_exp_f32 v21, v21
  v_exp_f32 v22, v22
  v_mfma_f32_32x32x16_bf16 v[2:17], v[114:117], v[98:101], 0
  s_waitcnt vmcnt(22) lgkmcnt(1)
  ds_read_b128 v[126:129], v186 offset:1280
  ds_read_b128 v[134:137], v186 offset:1920
  v_exp_f32 v23, v23
  v_exp_f32 v24, v24
  v_mfma_f32_32x32x16_bf16 v[66:81], a[36:39], v[142:145], v[66:81]
  ds_read_b128 v[138:141], v174 offset:16384
  v_exp_f32 v25, v25
  v_exp_f32 v26, v26
  v_exp_f32 v27, v27
  v_mfma_f32_32x32x8_bf16 v[2:17], v[120:121], v[106:107], v[2:17]
  v_exp_f32 v28, v28
  v_exp_f32 v29, v29
  v_exp_f32 v30, v30
  v_exp_f32 v31, v31
  v_smfmac_f32_32x32x32_bf16 v[50:65], v[122:125], v[18:25], v202
  s_waitcnt lgkmcnt(3)
  buffer_load_dwordx4 v192, s[20:23], s50 offen offset:3072 sc1 lds
  v_exp_f32 v32, v32
  v_exp_f32 v33, v33
  v_mfma_f32_32x32x16_bf16 v[82:97], a[36:39], v[150:153], v[82:97]
  ds_read_b128 v[146:149], v174 offset:24576
  v_exp_f32 v2, v2
  v_exp_f32 v3, v3
  v_exp_f32 v4, v4
  v_smfmac_f32_32x32x32_bf16 v[50:65], v[130:133], v[26:33], v202
  s_add_u32 s51, s51, s53
  buffer_load_dwordx4 a[24:27], v196, s[28:31], s52 offen offset:2048 sc1
  v_exp_f32 v5, v5
  v_exp_f32 v6, v6
  v_mfma_f32_32x32x16_bf16 v[18:33], v[114:117], v[102:105], 0
  s_waitcnt vmcnt(23) lgkmcnt(1)
  ds_read_b128 v[110:113], v180 offset:15360
  ds_read_b64 v[118:119], v182 offset:3072
  v_exp_f32 v7, v7
  v_exp_f32 v8, v8
  v_mfma_f32_32x32x16_bf16 v[66:81], a[40:43], v[138:141], v[66:81]
  s_add_u32 m0, s55, 36864
  ds_read_b128 v[142:145], v175 offset:16384
  v_exp_f32 v9, v9
  v_exp_f32 v10, v10
  v_exp_f32 v11, v11
  v_mfma_f32_32x32x8_bf16 v[18:33], v[120:121], v[108:109], v[18:33]
  v_exp_f32 v12, v12
  v_exp_f32 v13, v13
  v_exp_f32 v14, v14
  v_exp_f32 v15, v15
  v_smfmac_f32_32x32x32_bf16 v[34:49], v[126:129], v[2:9], v202
  s_waitcnt lgkmcnt(3)
  buffer_load_dwordx4 v193, s[24:27], s51 offen offset:0 sc1 lds
  v_exp_f32 v16, v16
  v_exp_f32 v17, v17
  v_mfma_f32_32x32x16_bf16 v[82:97], a[40:43], v[146:149], v[82:97]
  ds_read_b128 v[150:153], v175 offset:24576
  v_exp_f32 v18, v18
  v_exp_f32 v19, v19
  v_exp_f32 v20, v20
  v_smfmac_f32_32x32x32_bf16 v[34:49], v[134:137], v[10:17], v202
  s_waitcnt lgkmcnt(3)
  buffer_load_dwordx4 a[28:31], v196, s[28:31], s52 offen offset:3072 sc1
  v_exp_f32 v21, v21
  v_exp_f32 v22, v22
  v_mfma_f32_32x32x16_bf16 v[2:17], v[110:113], v[98:101], 0
  s_waitcnt vmcnt(24) lgkmcnt(1)
  ds_read_b128 v[122:125], v186 offset:2560
  ds_read_b128 v[130:133], v186 offset:3200
  v_exp_f32 v23, v23
  v_exp_f32 v24, v24
  v_mfma_f32_32x32x16_bf16 v[66:81], a[44:47], v[142:145], v[66:81]
  ds_read_b128 v[138:141], v176 offset:16384
  v_exp_f32 v25, v25
  v_exp_f32 v26, v26
  v_exp_f32 v27, v27
  v_mfma_f32_32x32x8_bf16 v[2:17], v[118:119], v[106:107], v[2:17]
  v_exp_f32 v28, v28
  v_exp_f32 v29, v29
  v_exp_f32 v30, v30
  v_exp_f32 v31, v31
  v_smfmac_f32_32x32x32_bf16 v[50:65], v[126:129], v[18:25], v202
  s_waitcnt lgkmcnt(3)
  buffer_load_dwordx4 v194, s[24:27], s51 offen offset:1024 sc1 lds
  v_exp_f32 v32, v32
  v_exp_f32 v33, v33
  v_mfma_f32_32x32x16_bf16 v[82:97], a[44:47], v[150:153], v[82:97]
  s_add_u32 s52, s52, 4096
  ds_read_b128 v[146:149], v176 offset:24576
  v_exp_f32 v2, v2
  v_exp_f32 v3, v3
  v_exp_f32 v4, v4
  v_smfmac_f32_32x32x32_bf16 v[50:65], v[134:137], v[26:33], v202
  s_cmp_eq_u32 s56, 3
  buffer_load_dwordx4 a[32:35], v196, s[28:31], s52 offen offset:0 sc1
  v_exp_f32 v5, v5
  v_exp_f32 v6, v6
  v_mfma_f32_32x32x16_bf16 v[18:33], v[110:113], v[102:105], 0
  s_waitcnt vmcnt(25) lgkmcnt(1)
  ds_read_b128 v[114:117], v180 offset:16896
  ds_read_b64 v[120:121], v182 offset:4608
  v_exp_f32 v7, v7
  v_exp_f32 v8, v8
  v_mfma_f32_32x32x16_bf16 v[66:81], a[48:51], v[138:141], v[66:81]
  ds_read_b128 v[142:145], v177 offset:16384
  v_exp_f32 v9, v9
  v_exp_f32 v10, v10
  v_exp_f32 v11, v11
  v_mfma_f32_32x32x8_bf16 v[18:33], v[118:119], v[108:109], v[18:33]
  v_exp_f32 v12, v12
  v_exp_f32 v13, v13
  v_exp_f32 v14, v14
  v_exp_f32 v15, v15
  v_smfmac_f32_32x32x32_bf16 v[34:49], v[122:125], v[2:9], v202
  s_waitcnt lgkmcnt(3)
  buffer_load_dwordx4 v195, s[24:27], s51 offen offset:2048 sc1 lds
  v_exp_f32 v16, v16
  v_exp_f32 v17, v17
  v_mfma_f32_32x32x16_bf16 v[82:97], a[48:51], v[146:149], v[82:97]
  s_cbranch_scc1 k2_sw
k2_swr:
  s_add_u32 s50, s50, s58
  ds_read_b128 v[150:153], v177 offset:24576
  v_exp_f32 v18, v18
  v_exp_f32 v19, v19
  v_exp_f32 v20, v20
  v_smfmac_f32_32x32x32_bf16 v[34:49], v[130:133], v[10:17], v202
  s_waitcnt lgkmcnt(3)
  buffer_load_dwordx4 a[36:39], v196, s[28:31], s52 offen offset:1024 sc1
  v_exp_f32 v21, v21
  v_exp_f32 v22, v22
  v_mfma_f32_32x32x16_bf16 v[2:17], v[114:117], v[98:101], 0
  s_waitcnt vmcnt(25) lgkmcnt(1)
  ds_read_b128 v[126:129], v186 offset:3840
  ds_read_b128 v[134:137], v186 offset:4480
  v_exp_f32 v23, v23
  v_exp_f32 v24, v24
  v_mfma_f32_32x32x16_bf16 v[66:81], a[52:55], v[142:145], v[66:81]
  ds_read_b128 v[138:141], v178 offset:16384
  v_exp_f32 v25, v25
  v_exp_f32 v26, v26
  v_exp_f32 v27, v27
  v_mfma_f32_32x32x8_bf16 v[2:17], v[120:121], v[106:107], v[2:17]
  v_exp_f32 v28, v28
  v_exp_f32 v29, v29
  v_exp_f32 v30, v30
  v_exp_f32 v31, v31
  v_smfmac_f32_32x32x32_bf16 v[50:65], v[122:125], v[18:25], v202
  s_waitcnt lgkmcnt(3)
  buffer_load_dwordx4 v[162:165], v199, s[32:35], s19 offen offset:0 sc1
  buffer_load_dwordx4 v[166:169], v199, s[32:35], s19 offen offset:1024 sc1
  v_exp_f32 v32, v32
  v_exp_f32 v33, v33
  v_mfma_f32_32x32x16_bf16 v[82:97], a[52:55], v[150:153], v[82:97]
  ds_read_b128 v[146:149], v178 offset:24576
  v_exp_f32 v2, v2
  v_exp_f32 v3, v3
  v_exp_f32 v4, v4
  v_smfmac_f32_32x32x32_bf16 v[50:65], v[130:133], v[26:33], v202
  s_waitcnt vmcnt(20)
  s_barrier
  buffer_load_dwordx4 a[40:43], v196, s[28:31], s52 offen offset:2048 sc1
  v_exp_f32 v5, v5
  v_exp_f32 v6, v6
  v_mfma_f32_32x32x16_bf16 v[18:33], v[114:117], v[102:105], 0
  s_waitcnt lgkmcnt(1)
  ds_read_b128 v[110:113], v180 offset:24576
  ds_read_b64 v[118:119], v183 offset:0
  v_exp_f32 v7, v7
  v_exp_f32 v8, v8
  v_mfma_f32_32x32x16_bf16 v[66:81], a[56:59], v[138:141], v[66:81]
  s_add_u32 m0, s54, 0
  ds_read_b128 v[142:145], v179 offset:16384
  v_exp_f32 v9, v9
  v_exp_f32 v10, v10
  v_exp_f32 v11, v11
  v_mfma_f32_32x32x8_bf16 v[18:33], v[120:121], v[108:109], v[18:33]
  v_exp_f32 v12, v12
  v_exp_f32 v13, v13
  v_exp_f32 v14, v14
  v_exp_f32 v15, v15
  v_smfmac_f32_32x32x32_bf16 v[34:49], v[126:129], v[2:9], v202
  s_waitcnt lgkmcnt(3)
  buffer_load_dwordx4 v189, s[20:23], s50 offen offset:0 sc1 lds
  v_exp_f32 v16, v16
  v_exp_f32 v17, v17
  v_mfma_f32_32x32x16_bf16 v[82:97], a[56:59], v[146:149], v[82:97]
  ds_read_b128 v[150:153], v179 offset:24576
  v_exp_f32 v18, v18
  v_exp_f32 v19, v19
  v_exp_f32 v20, v20
  v_smfmac_f32_32x32x32_bf16 v[34:49], v[134:137], v[10:17], v202
  s_waitcnt lgkmcnt(3)
  buffer_load_dwordx4 a[44:47], v196, s[28:31], s52 offen offset:3072 sc1
  v_exp_f32 v21, v21
  v_exp_f32 v22, v22
  v_mfma_f32_32x32x16_bf16 v[2:17], v[110:113], v[98:101], 0
  s_waitcnt lgkmcnt(1)
  ds_read_b128 v[122:125], v187 offset:0
  ds_read_b128 v[130:133], v187 offset:640
  v_exp_f32 v23, v23
  v_exp_f32 v24, v24
  v_mfma_f32_32x32x16_bf16 v[66:81], a[60:63], v[142:145], v[66:81]
  ds_read_b128 v[138:141], v172 offset:32768
  v_exp_f32 v25, v25
  v_exp_f32 v26, v26
  v_exp_f32 v27, v27
  v_mfma_f32_32x32x8_bf16 v[2:17], v[118:119], v[106:107], v[2:17]
  v_exp_f32 v28, v28
  v_exp_f32 v29, v29
  v_exp_f32 v30, v30
  v_exp_f32 v31, v31
  v_smfmac_f32_32x32x32_bf16 v[50:65], v[126:129], v[18:25], v202
  s_waitcnt lgkmcnt(3)
  buffer_load_dwordx4 v190, s[20:23], s50 offen offset:1024 sc1 lds
  v_exp_f32 v32, v32
  v_exp_f32 v33, v33
  v_mfma_f32_32x32x16_bf16 v[82:97], a[60:63], v[150:153], v[82:97]
  s_add_u32 s52, s52, 4096
  ds_read_b128 v[146:149], v172 offset:40960
  v_exp_f32 v2, v2
  v_exp_f32 v3, v3
  v_exp_f32 v4, v4
  v_smfmac_f32_32x32x32_bf16 v[50:65], v[134:137], v[26:33], v202
  buffer_load_dwordx4 a[48:51], v196, s[28:31], s52 offen offset:0 sc1
  v_exp_f32 v5, v5
  v_exp_f32 v6, v6
  v_mfma_f32_32x32x16_bf16 v[18:33], v[110:113], v[102:105], 0
  s_waitcnt lgkmcnt(1)
  ds_read_b128 v[114:117], v180 offset:26112
  ds_read_b64 v[120:121], v183 offset:1536
  v_exp_f32 v7, v7
  v_exp_f32 v8, v8
  v_mfma_f32_32x32x16_bf16 v[66:81], a[0:3], v[138:141], v[66:81]
  ds_read_b128 v[142:145], v173 offset:32768
  v_exp_f32 v9, v9
  v_exp_f32 v10, v10
  v_exp_f32 v11, v11
  v_mfma_f32_32x32x8_bf16 v[18:33], v[118:119], v[108:109], v[18:33]
  v_exp_f32 v12, v12
  v_exp_f32 v13, v13
  v_exp_f32 v14, v14
  v_exp_f32 v15, v15
  v_smfmac_f32_32x32x32_bf16 v[34:49], v[122:125], v[2:9], v202
  s_waitcnt lgkmcnt(3)
  buffer_load_dwordx4 v191, s[20:23], s50 offen offset:2048 sc1 lds
  v_exp_f32 v16, v16
  v_exp_f32 v17, v17
  v_mfma_f32_32x32x16_bf16 v[82:97], a[0:3], v[146:149], v[82:97]
  ds_read_b128 v[150:153], v173 offset:40960
  v_exp_f32 v18, v18
  v_exp_f32 v19, v19
  v_exp_f32 v20, v20
  v_smfmac_f32_32x32x32_bf16 v[34:49], v[130:133], v[10:17], v202
  s_waitcnt lgkmcnt(3)
  buffer_load_dwordx4 a[52:55], v196, s[28:31], s52 offen offset:1024 sc1
  v_exp_f32 v21, v21
  v_exp_f32 v22, v22
  v_mfma_f32_32x32x16_bf16 v[2:17], v[114:117], v[98:101], 0
  s_waitcnt vmcnt(26) lgkmcnt(1)
  ds_read_b128 v[126:129], v187 offset:1280
  ds_read_b128 v[134:137], v187 offset:1920
  v_exp_f32 v23, v23
  v_exp_f32 v24, v24
  v_mfma_f32_32x32x16_bf16 v[66:81], a[4:7], v[142:145], v[66:81]
  ds_read_b128 v[138:141], v174 offset:32768
  v_exp_f32 v25, v25
  v_exp_f32 v26, v26
  v_exp_f32 v27, v27
  v_mfma_f32_32x32x8_bf16 v[2:17], v[120:121], v[106:107], v[2:17]
  v_exp_f32 v28, v28
  v_exp_f32 v29, v29
  v_exp_f32 v30, v30
  v_exp_f32 v31, v31
  v_smfmac_f32_32x32x32_bf16 v[50:65], v[122:125], v[18:25], v202
  s_waitcnt lgkmcnt(3)
  buffer_load_dwordx4 v192, s[20:23], s50 offen offset:3072 sc1 lds
  v_exp_f32 v32, v32
  v_exp_f32 v33, v33
  v_mfma_f32_32x32x16_bf16 v[82:97], a[4:7], v[150:153], v[82:97]
  ds_read_b128 v[146:149], v174 offset:40960
  v_exp_f32 v2, v2
  v_exp_f32 v3, v3
  v_exp_f32 v4, v4
  v_smfmac_f32_32x32x32_bf16 v[50:65], v[130:133], v[26:33], v202
  s_add_u32 s51, s51, s53
  buffer_load_dwordx4 a[56:59], v196, s[28:31], s52 offen offset:2048 sc1
  v_exp_f32 v5, v5
  v_exp_f32 v6, v6
  v_mfma_f32_32x32x16_bf16 v[18:33], v[114:117], v[102:105], 0
  s_waitcnt vmcnt(25) lgkmcnt(1)
  ds_read_b128 v[110:113], v180 offset:27648
  ds_read_b64 v[118:119], v183 offset:3072
  v_exp_f32 v7, v7
  v_exp_f32 v8, v8
  v_mfma_f32_32x32x16_bf16 v[66:81], a[8:11], v[138:141], v[66:81]
  s_add_u32 m0, s55, 0
  ds_read_b128 v[142:145], v175 offset:32768
  v_exp_f32 v9, v9
  v_exp_f32 v10, v10
  v_exp_f32 v11, v11
  v_mfma_f32_32x32x8_bf16 v[18:33], v[120:121], v[108:109], v[18:33]
  v_exp_f32 v12, v12
  v_exp_f32 v13, v13
  v_exp_f32 v14, v14
  v_exp_f32 v15, v15
  v_smfmac_f32_32x32x32_bf16 v[34:49], v[126:129], v[2:9], v202
  s_waitcnt lgkmcnt(3)
  buffer_load_dwordx4 v193, s[24:27], s51 offen offset:0 sc1 lds
  v_exp_f32 v16, v16
  v_exp_f32 v17, v17
  v_mfma_f32_32x32x16_bf16 v[82:97], a[8:11], v[146:149], v[82:97]
  s_cmp_eq_u32 s56, 3
  ds_read_b128 v[150:153], v175 offset:40960
  v_exp_f32 v18, v18
  v_exp_f32 v19, v19
  v_exp_f32 v20, v20
  v_smfmac_f32_32x32x32_bf16 v[34:49], v[134:137], v[10:17], v202
  s_waitcnt lgkmcnt(3)
  buffer_load_dwordx4 a[60:63], v196, s[28:31], s52 offen offset:3072 sc1
  v_exp_f32 v21, v21
  v_exp_f32 v22, v22
  v_mfma_f32_32x32x16_bf16 v[2:17], v[110:113], v[98:101], 0
  s_waitcnt vmcnt(25) lgkmcnt(1)
  ds_read_b128 v[122:125], v187 offset:2560
  ds_read_b128 v[130:133], v187 offset:3200
  v_exp_f32 v23, v23
  v_exp_f32 v24, v24
  v_mfma_f32_32x32x16_bf16 v[66:81], a[12:15], v[142:145], v[66:81]
  s_cselect_b32 s30, 0, s30
  ds_read_b128 v[138:141], v176 offset:32768
  v_exp_f32 v25, v25
  v_exp_f32 v26, v26
  v_exp_f32 v27, v27
  v_mfma_f32_32x32x8_bf16 v[2:17], v[118:119], v[106:107], v[2:17]
  v_exp_f32 v28, v28
  v_exp_f32 v29, v29
  v_exp_f32 v30, v30
  v_exp_f32 v31, v31
  v_smfmac_f32_32x32x32_bf16 v[50:65], v[126:129], v[18:25], v202
  s_waitcnt lgkmcnt(3)
  buffer_load_dwordx4 v194, s[24:27], s51 offen offset:1024 sc1 lds
  v_exp_f32 v32, v32
  v_exp_f32 v33, v33
  v_mfma_f32_32x32x16_bf16 v[82:97], a[12:15], v[150:153], v[82:97]
  s_add_u32 s52, s52, 4096
  ds_read_b128 v[146:149], v176 offset:40960
  v_exp_f32 v2, v2
  v_exp_f32 v3, v3
  v_exp_f32 v4, v4
  v_smfmac_f32_32x32x32_bf16 v[50:65], v[134:137], v[26:33], v202
  buffer_load_dwordx4 a[0:3], v196, s[28:31], s52 offen offset:0 sc1
  v_exp_f32 v5, v5
  v_exp_f32 v6, v6
  v_mfma_f32_32x32x16_bf16 v[18:33], v[110:113], v[102:105], 0
  s_waitcnt vmcnt(25) lgkmcnt(1)
  ds_read_b128 v[114:117], v180 offset:29184
  ds_read_b64 v[120:121], v183 offset:4608
  v_exp_f32 v7, v7
  v_exp_f32 v8, v8
  v_mfma_f32_32x32x16_bf16 v[66:81], a[16:19], v[138:141], v[66:81]
  ds_read_b128 v[142:145], v177 offset:32768
  v_exp_f32 v9, v9
  v_exp_f32 v10, v10
  v_exp_f32 v11, v11
  v_mfma_f32_32x32x8_bf16 v[18:33], v[118:119], v[108:109], v[18:33]
  v_exp_f32 v12, v12
  v_exp_f32 v13, v13
  v_exp_f32 v14, v14
  v_exp_f32 v15, v15
  v_smfmac_f32_32x32x32_bf16 v[34:49], v[122:125], v[2:9], v202
  s_waitcnt lgkmcnt(3)
  buffer_load_dwordx4 v195, s[24:27], s51 offen offset:2048 sc1 lds
  v_exp_f32 v16, v16
  v_exp_f32 v17, v17
  v_mfma_f32_32x32x16_bf16 v[82:97], a[16:19], v[146:149], v[82:97]
  s_add_u32 s50, s50, s58
  ds_read_b128 v[150:153], v177 offset:40960
  v_exp_f32 v18, v18
  v_exp_f32 v19, v19
  v_exp_f32 v20, v20
  v_smfmac_f32_32x32x32_bf16 v[34:49], v[130:133], v[10:17], v202
  s_waitcnt lgkmcnt(3)
  s_add_u32 s61, s61, 4096
  buffer_load_dwordx4 a[4:7], v196, s[28:31], s52 offen offset:1024 sc1
  v_exp_f32 v21, v21
  v_exp_f32 v22, v22
  v_mfma_f32_32x32x16_bf16 v[2:17], v[114:117], v[98:101], 0
  s_waitcnt vmcnt(25) lgkmcnt(1)
  ds_read_b128 v[126:129], v187 offset:3840
  ds_read_b128 v[134:137], v187 offset:4480
  v_exp_f32 v23, v23
  v_exp_f32 v24, v24
  v_mfma_f32_32x32x16_bf16 v[66:81], a[20:23], v[142:145], v[66:81]
  s_add_u32 m0, s62, s61
  ds_read_b128 v[138:141], v178 offset:32768
  v_exp_f32 v25, v25
  v_exp_f32 v26, v26
  v_exp_f32 v27, v27
  v_mfma_f32_32x32x8_bf16 v[2:17], v[120:121], v[106:107], v[2:17]
  v_exp_f32 v28, v28
  v_exp_f32 v29, v29
  v_exp_f32 v30, v30
  v_exp_f32 v31, v31
  v_smfmac_f32_32x32x32_bf16 v[50:65], v[122:125], v[18:25], v202
  s_waitcnt lgkmcnt(3)
  buffer_load_dwordx4 v216, s[40:43], s61 offen sc1 lds
  v_exp_f32 v32, v32
  v_exp_f32 v33, v33
  v_mfma_f32_32x32x16_bf16 v[82:97], a[20:23], v[150:153], v[82:97]
  ds_read_b128 v[146:149], v178 offset:40960
  v_exp_f32 v2, v2
  v_exp_f32 v3, v3
  v_exp_f32 v4, v4
  v_smfmac_f32_32x32x32_bf16 v[50:65], v[130:133], v[26:33], v202
  s_waitcnt vmcnt(19)
  s_barrier
  buffer_load_dwordx4 a[8:11], v196, s[28:31], s52 offen offset:2048 sc1
  v_exp_f32 v5, v5
  v_exp_f32 v6, v6
  v_mfma_f32_32x32x16_bf16 v[18:33], v[114:117], v[102:105], 0
  s_waitcnt lgkmcnt(1)
  ds_read_b128 v[110:113], v180 offset:36864
  ds_read_b64 v[118:119], v184 offset:0
  v_exp_f32 v7, v7
  v_exp_f32 v8, v8
  v_mfma_f32_32x32x16_bf16 v[66:81], a[24:27], v[138:141], v[66:81]
  s_add_u32 m0, s54, 16384
  ds_read_b128 v[142:145], v179 offset:32768
  v_exp_f32 v9, v9
  v_exp_f32 v10, v10
  v_exp_f32 v11, v11
  v_mfma_f32_32x32x8_bf16 v[18:33], v[120:121], v[108:109], v[18:33]
  v_exp_f32 v12, v12
  v_exp_f32 v13, v13
  v_exp_f32 v14, v14
  v_exp_f32 v15, v15
  v_smfmac_f32_32x32x32_bf16 v[34:49], v[126:129], v[2:9], v202
  s_waitcnt lgkmcnt(3)
  buffer_load_dwordx4 v189, s[20:23], s50 offen offset:0 sc1 lds
  v_exp_f32 v16, v16
  v_exp_f32 v17, v17
  v_mfma_f32_32x32x16_bf16 v[82:97], a[24:27], v[146:149], v[82:97]
  ds_read_b128 v[150:153], v179 offset:40960
  v_exp_f32 v18, v18
  v_exp_f32 v19, v19
  v_exp_f32 v20, v20
  v_smfmac_f32_32x32x32_bf16 v[34:49], v[134:137], v[10:17], v202
  s_waitcnt lgkmcnt(3)
  buffer_load_dwordx4 a[12:15], v196, s[28:31], s52 offen offset:3072 sc1
  v_exp_f32 v21, v21
  v_exp_f32 v22, v22
  v_mfma_f32_32x32x16_bf16 v[2:17], v[110:113], v[98:101], 0
  s_waitcnt lgkmcnt(1)
  ds_read_b128 v[122:125], v188 offset:0
  ds_read_b128 v[130:133], v188 offset:640
  v_exp_f32 v23, v23
  v_exp_f32 v24, v24
  v_mfma_f32_32x32x16_bf16 v[66:81], a[28:31], v[142:145], v[66:81]
  ds_read_b128 v[138:141], v172 offset:49152
  v_exp_f32 v25, v25
  v_exp_f32 v26, v26
  v_exp_f32 v27, v27
  v_mfma_f32_32x32x8_bf16 v[2:17], v[118:119], v[106:107], v[2:17]
  v_exp_f32 v28, v28
  v_exp_f32 v29, v29
  v_exp_f32 v30, v30
  v_exp_f32 v31, v31
  v_smfmac_f32_32x32x32_bf16 v[50:65], v[126:129], v[18:25], v202
  s_waitcnt lgkmcnt(3)
  buffer_load_dwordx4 v190, s[20:23], s50 offen offset:1024 sc1 lds
  v_exp_f32 v32, v32
  v_exp_f32 v33, v33
  v_mfma_f32_32x32x16_bf16 v[82:97], a[28:31], v[150:153], v[82:97]
  s_add_u32 s52, s52, 4096
  ds_read_b128 v[146:149], v172 offset:57344
  v_exp_f32 v2, v2
  v_exp_f32 v3, v3
  v_exp_f32 v4, v4
  v_smfmac_f32_32x32x32_bf16 v[50:65], v[134:137], v[26:33], v202
  buffer_load_dwordx4 a[16:19], v196, s[28:31], s52 offen offset:0 sc1
  v_exp_f32 v5, v5
  v_exp_f32 v6, v6
  v_mfma_f32_32x32x16_bf16 v[18:33], v[110:113], v[102:105], 0
  s_waitcnt lgkmcnt(1)
  ds_read_b128 v[114:117], v180 offset:38400
  ds_read_b64 v[120:121], v184 offset:1536
  v_exp_f32 v7, v7
  v_exp_f32 v8, v8
  v_mfma_f32_32x32x16_bf16 v[66:81], a[32:35], v[138:141], v[66:81]
  ds_read_b128 v[142:145], v173 offset:49152
  v_exp_f32 v9, v9
  v_exp_f32 v10, v10
  v_exp_f32 v11, v11
  v_mfma_f32_32x32x8_bf16 v[18:33], v[118:119], v[108:109], v[18:33]
  v_exp_f32 v12, v12
  v_exp_f32 v13, v13
  v_exp_f32 v14, v14
  v_exp_f32 v15, v15
  v_smfmac_f32_32x32x32_bf16 v[34:49], v[122:125], v[2:9], v202
  s_waitcnt lgkmcnt(3)
  buffer_load_dwordx4 v191, s[20:23], s50 offen offset:2048 sc1 lds
  v_exp_f32 v16, v16
  v_exp_f32 v17, v17
  v_mfma_f32_32x32x16_bf16 v[82:97], a[32:35], v[146:149], v[82:97]
  ds_read_b128 v[150:153], v173 offset:57344
  v_exp_f32 v18, v18
  v_exp_f32 v19, v19
  v_exp_f32 v20, v20
  v_smfmac_f32_32x32x32_bf16 v[34:49], v[130:133], v[10:17], v202
  s_waitcnt lgkmcnt(3)
  buffer_load_dwordx4 a[20:23], v196, s[28:31], s52 offen offset:1024 sc1
  v_exp_f32 v21, v21
  v_exp_f32 v22, v22
  v_mfma_f32_32x32x16_bf16 v[2:17], v[114:117], v[98:101], 0
  s_waitcnt vmcnt(25) lgkmcnt(1)
  ds_read_b128 v[126:129], v188 offset:1280
  ds_read_b128 v[134:137], v188 offset:1920
  v_exp_f32 v23, v23
  v_exp_f32 v24, v24
  v_mfma_f32_32x32x16_bf16 v[66:81], a[36:39], v[142:145], v[66:81]
  ds_read_b128 v[138:141], v174 offset:49152
  v_exp_f32 v25, v25
  v_exp_f32 v26, v26
  v_exp_f32 v27, v27
  v_mfma_f32_32x32x8_bf16 v[2:17], v[120:121], v[106:107], v[2:17]
  v_exp_f32 v28, v28
  v_exp_f32 v29, v29
  v_exp_f32 v30, v30
  v_exp_f32 v31, v31
  v_smfmac_f32_32x32x32_bf16 v[50:65], v[122:125], v[18:25], v202
  s_waitcnt lgkmcnt(3)
  buffer_load_dwordx4 v192, s[20:23], s50 offen offset:3072 sc1 lds
  v_exp_f32 v32, v32
  v_exp_f32 v33, v33
  v_mfma_f32_32x32x16_bf16 v[82:97], a[36:39], v[150:153], v[82:97]
  ds_read_b128 v[146:149], v174 offset:57344
  v_exp_f32 v2, v2
  v_exp_f32 v3, v3
  v_exp_f32 v4, v4
  v_smfmac_f32_32x32x32_bf16 v[50:65], v[130:133], v[26:33], v202
  s_add_u32 s51, s51, s53
  buffer_load_dwordx4 a[24:27], v196, s[28:31], s52 offen offset:2048 sc1
  v_exp_f32 v5, v5
  v_exp_f32 v6, v6
  v_mfma_f32_32x32x16_bf16 v[18:33], v[114:117], v[102:105], 0
  s_waitcnt vmcnt(24) lgkmcnt(1)
  ds_read_b128 v[110:113], v180 offset:39936
  ds_read_b64 v[118:119], v184 offset:3072
  v_exp_f32 v7, v7
  v_exp_f32 v8, v8
  v_mfma_f32_32x32x16_bf16 v[66:81], a[40:43], v[138:141], v[66:81]
  s_add_u32 m0, s55, 12288
  ds_read_b128 v[142:145], v175 offset:49152
  v_exp_f32 v9, v9
  v_exp_f32 v10, v10
  v_exp_f32 v11, v11
  v_mfma_f32_32x32x8_bf16 v[18:33], v[120:121], v[108:109], v[18:33]
  v_exp_f32 v12, v12
  v_exp_f32 v13, v13
  v_exp_f32 v14, v14
  v_exp_f32 v15, v15
  v_smfmac_f32_32x32x32_bf16 v[34:49], v[126:129], v[2:9], v202
  s_waitcnt lgkmcnt(3)
  buffer_load_dwordx4 v193, s[24:27], s51 offen offset:0 sc1 lds
  v_exp_f32 v16, v16
  v_exp_f32 v17, v17
  v_mfma_f32_32x32x16_bf16 v[82:97], a[40:43], v[146:149], v[82:97]
  ds_read_b128 v[150:153], v175 offset:57344
  v_exp_f32 v18, v18
  v_exp_f32 v19, v19
  v_exp_f32 v20, v20
  v_smfmac_f32_32x32x32_bf16 v[34:49], v[134:137], v[10:17], v202
  s_waitcnt lgkmcnt(3)
  buffer_load_dwordx4 a[28:31], v196, s[28:31], s52 offen offset:3072 sc1
  v_exp_f32 v21, v21
  v_exp_f32 v22, v22
  v_mfma_f32_32x32x16_bf16 v[2:17], v[110:113], v[98:101], 0
  s_waitcnt vmcnt(24) lgkmcnt(1)
  ds_read_b128 v[122:125], v188 offset:2560
  ds_read_b128 v[130:133], v188 offset:3200
  v_exp_f32 v23, v23
  v_exp_f32 v24, v24
  v_mfma_f32_32x32x16_bf16 v[66:81], a[44:47], v[142:145], v[66:81]
  ds_read_b128 v[138:141], v176 offset:49152
  v_exp_f32 v25, v25
  v_exp_f32 v26, v26
  v_exp_f32 v27, v27
  v_mfma_f32_32x32x8_bf16 v[2:17], v[118:119], v[106:107], v[2:17]
  v_exp_f32 v28, v28
  v_exp_f32 v29, v29
  v_exp_f32 v30, v30
  v_exp_f32 v31, v31
  v_smfmac_f32_32x32x32_bf16 v[50:65], v[126:129], v[18:25], v202
  s_waitcnt lgkmcnt(3)
  buffer_load_dwordx4 v194, s[24:27], s51 offen offset:1024 sc1 lds
  v_exp_f32 v32, v32
  v_exp_f32 v33, v33
  v_mfma_f32_32x32x16_bf16 v[82:97], a[44:47], v[150:153], v[82:97]
  s_add_u32 s52, s52, 4096
  ds_read_b128 v[146:149], v176 offset:57344
  v_exp_f32 v2, v2
  v_exp_f32 v3, v3
  v_exp_f32 v4, v4
  v_smfmac_f32_32x32x32_bf16 v[50:65], v[134:137], v[26:33], v202
  s_add_u32 s56, s56, 1
  buffer_load_dwordx4 a[32:35], v196, s[28:31], s52 offen offset:0 sc1
  v_exp_f32 v5, v5
  v_exp_f32 v6, v6
  v_mfma_f32_32x32x16_bf16 v[18:33], v[110:113], v[102:105], 0
  s_waitcnt vmcnt(24) lgkmcnt(1)
  ds_read_b128 v[114:117], v180 offset:41472
  ds_read_b64 v[120:121], v184 offset:4608
  v_exp_f32 v7, v7
  v_exp_f32 v8, v8
  v_mfma_f32_32x32x16_bf16 v[66:81], a[48:51], v[138:141], v[66:81]
  ds_read_b128 v[142:145], v177 offset:49152
  v_exp_f32 v9, v9
  v_exp_f32 v10, v10
  v_exp_f32 v11, v11
  v_mfma_f32_32x32x8_bf16 v[18:33], v[118:119], v[108:109], v[18:33]
  v_exp_f32 v12, v12
  v_exp_f32 v13, v13
  v_exp_f32 v14, v14
  v_exp_f32 v15, v15
  v_smfmac_f32_32x32x32_bf16 v[34:49], v[122:125], v[2:9], v202
  s_waitcnt lgkmcnt(3)
  buffer_load_dwordx4 v195, s[24:27], s51 offen offset:2048 sc1 lds
  v_exp_f32 v16, v16
  v_exp_f32 v17, v17
  v_mfma_f32_32x32x16_bf16 v[82:97], a[48:51], v[146:149], v[82:97]
  s_add_u32 s50, s50, s58
  ds_read_b128 v[150:153], v177 offset:57344
  v_exp_f32 v18, v18
  v_exp_f32 v19, v19
  v_exp_f32 v20, v20
  v_smfmac_f32_32x32x32_bf16 v[34:49], v[130:133], v[10:17], v202
  s_waitcnt lgkmcnt(3)
  s_add_u32 s61, s61, 4096
  buffer_load_dwordx4 a[36:39], v196, s[28:31], s52 offen offset:1024 sc1
  v_exp_f32 v21, v21
  v_exp_f32 v22, v22
  v_mfma_f32_32x32x16_bf16 v[2:17], v[114:117], v[98:101], 0
  s_waitcnt vmcnt(24) lgkmcnt(1)
  ds_read_b128 v[126:129], v188 offset:3840
  ds_read_b128 v[134:137], v188 offset:4480
  v_exp_f32 v23, v23
  v_exp_f32 v24, v24
  v_mfma_f32_32x32x16_bf16 v[66:81], a[52:55], v[142:145], v[66:81]
  s_add_u32 m0, s62, s61
  ds_read_b128 v[138:141], v178 offset:49152
  v_exp_f32 v25, v25
  v_exp_f32 v26, v26
  v_exp_f32 v27, v27
  v_mfma_f32_32x32x8_bf16 v[2:17], v[120:121], v[106:107], v[2:17]
  v_exp_f32 v28, v28
  v_exp_f32 v29, v29
  v_exp_f32 v30, v30
  v_exp_f32 v31, v31
  v_smfmac_f32_32x32x32_bf16 v[50:65], v[122:125], v[18:25], v202
  s_waitcnt lgkmcnt(3)
  buffer_load_dwordx4 v216, s[40:43], s61 offen sc1 lds
  v_exp_f32 v32, v32
  v_exp_f32 v33, v33
  v_mfma_f32_32x32x16_bf16 v[82:97], a[52:55], v[150:153], v[82:97]
  ds_read_b128 v[146:149], v178 offset:57344
  v_exp_f32 v2, v2
  v_exp_f32 v3, v3
  v_exp_f32 v4, v4
  v_smfmac_f32_32x32x32_bf16 v[50:65], v[130:133], v[26:33], v202
  s_waitcnt vmcnt(18)
  s_barrier
  buffer_load_dwordx4 a[40:43], v196, s[28:31], s52 offen offset:2048 sc1
  v_exp_f32 v5, v5
  v_exp_f32 v6, v6
  v_mfma_f32_32x32x16_bf16 v[18:33], v[114:117], v[102:105], 0
  s_waitcnt lgkmcnt(1)
  ds_read_b128 v[110:113], v180 offset:0
  ds_read_b64 v[118:119], v181 offset:0
  v_exp_f32 v7, v7
  v_exp_f32 v8, v8
  v_mfma_f32_32x32x16_bf16 v[66:81], a[56:59], v[138:141], v[66:81]
  s_add_u32 m0, s54, 32768
  ds_read_b128 v[142:145], v179 offset:49152
  v_exp_f32 v9, v9
  v_exp_f32 v10, v10
  v_exp_f32 v11, v11
  v_mfma_f32_32x32x8_bf16 v[18:33], v[120:121], v[108:109], v[18:33]
  v_exp_f32 v12, v12
  v_exp_f32 v13, v13
  v_exp_f32 v14, v14
  v_exp_f32 v15, v15
  v_smfmac_f32_32x32x32_bf16 v[34:49], v[126:129], v[2:9], v202
  s_waitcnt lgkmcnt(3)
  buffer_load_dwordx4 v189, s[20:23], s50 offen offset:0 sc1 lds
  v_exp_f32 v16, v16
  v_exp_f32 v17, v17
  v_mfma_f32_32x32x16_bf16 v[82:97], a[56:59], v[146:149], v[82:97]
  ds_read_b128 v[150:153], v179 offset:57344
  v_exp_f32 v18, v18
  v_exp_f32 v19, v19
  v_exp_f32 v20, v20
  v_smfmac_f32_32x32x32_bf16 v[34:49], v[134:137], v[10:17], v202
  s_waitcnt lgkmcnt(3)
  buffer_load_dwordx4 a[44:47], v196, s[28:31], s52 offen offset:3072 sc1
  v_exp_f32 v21, v21
  v_exp_f32 v22, v22
  v_mfma_f32_32x32x16_bf16 v[2:17], v[110:113], v[98:101], 0
  s_waitcnt lgkmcnt(1)
  ds_read_b128 v[122:125], v185 offset:0
  ds_read_b128 v[130:133], v185 offset:640
  v_exp_f32 v23, v23
  v_exp_f32 v24, v24
  v_mfma_f32_32x32x16_bf16 v[66:81], a[60:63], v[142:145], v[66:81]
  s_cmp_lt_u32 s56, 4
  ds_read_b128 v[138:141], v172 offset:0
  v_exp_f32 v25, v25
  v_exp_f32 v26, v26
  v_exp_f32 v27, v27
  v_mfma_f32_32x32x8_bf16 v[2:17], v[118:119], v[106:107], v[2:17]
  v_exp_f32 v28, v28
  v_exp_f32 v29, v29
  v_exp_f32 v30, v30
  v_exp_f32 v31, v31
  v_smfmac_f32_32x32x32_bf16 v[50:65], v[126:129], v[18:25], v202
  s_waitcnt lgkmcnt(3)
  buffer_load_dwordx4 v190, s[20:23], s50 offen offset:1024 sc1 lds
  v_exp_f32 v32, v32
  v_exp_f32 v33, v33
  s_cbranch_scc1 k2_loop
k2_lx:
  v_mfma_f32_32x32x16_bf16 v[82:97], a[60:63], v[150:153], v[82:97]
  buffer_load_dwordx4 v191, s[20:23], s50 offen offset:2048 sc1 lds
  v_smfmac_f32_32x32x32_bf16 v[50:65], v[134:137], v[26:33], v202
  buffer_load_dwordx4 v192, s[20:23], s50 offen offset:3072 sc1 lds
  s_mov_b32 s47, 0x2b800000
  s_mov_b32 s48, 0x53800000
  s_mov_b32 s49, 0xffff0000
  s_waitcnt lgkmcnt(0)
  v_lshlrev_b32 v2, 16, v154
  v_and_b32 v3, s49, v154
  v_lshlrev_b32 v4, 16, v155
  v_and_b32 v5, s49, v155
  v_lshlrev_b32 v6, 16, v156
  v_and_b32 v7, s49, v156
  v_lshlrev_b32 v8, 16, v157
  v_and_b32 v9, s49, v157
  v_lshlrev_b32 v10, 16, v158
  v_and_b32 v11, s49, v158
  v_lshlrev_b32 v12, 16, v159
  v_and_b32 v13, s49, v159
  v_lshlrev_b32 v14, 16, v160
  v_and_b32 v15, s49, v160
  v_lshlrev_b32 v16, 16, v161
  v_and_b32 v17, s49, v161
  v_cmp_le_f32 vcc, s47, v46
  v_cmp_ge_f32 s[64:65], s48, v46
  s_and_b64 s[66:67], vcc, s[64:65]
  v_cmp_le_f32 vcc, s47, v62
  v_cmp_ge_f32 s[64:65], s48, v62
  s_and_b64 s[66:67], vcc, s[66:67]
  s_and_b64 s[66:67], s[64:65], s[66:67]
  v_mov_b32 v213, 119808
  s_cmp_eq_u64 s[66:67], -1
  s_cbranch_scc1 k2_ok
  ds_write_b32 v213, v213
  s_waitcnt lgkmcnt(0)
k2_ok:
  s_barrier
  ds_read_b32 v214, v213
  v_lshlrev_b32 v18, 16, v162
  v_and_b32 v19, s49, v162
  v_lshlrev_b32 v20, 16, v163
  v_and_b32 v21, s49, v163
  v_lshlrev_b32 v22, 16, v164
  v_and_b32 v23, s49, v164
  v_lshlrev_b32 v24, 16, v165
  v_and_b32 v25, s49, v165
  v_lshlrev_b32 v26, 16, v166
  v_and_b32 v27, s49, v166
  v_lshlrev_b32 v28, 16, v167
  v_and_b32 v29, s49, v167
  v_lshlrev_b32 v30, 16, v168
  v_and_b32 v31, s49, v168
  v_lshlrev_b32 v32, 16, v169
  v_and_b32 v33, s49, v169
  s_mov_b32 s47, 8388608
  s_mov_b32 s48, 8443904
  v_pk_mul_f32 v[66:67], v[66:67], v[2:3]
  v_pk_mul_f32 v[68:69], v[68:69], v[4:5]
  v_pk_mul_f32 v[70:71], v[70:71], v[6:7]
  v_pk_mul_f32 v[72:73], v[72:73], v[8:9]
  v_pk_mul_f32 v[74:75], v[74:75], v[10:11]
  v_pk_mul_f32 v[76:77], v[76:77], v[12:13]
  v_pk_mul_f32 v[78:79], v[78:79], v[14:15]
  v_pk_mul_f32 v[80:81], v[80:81], v[16:17]
  v_cvt_pk_bf16_f32 v2, v66, v67
  v_cvt_pk_bf16_f32 v3, v68, v69
  v_cvt_pk_bf16_f32 v4, v70, v71
  v_cvt_pk_bf16_f32 v5, v72, v73
  v_cvt_pk_bf16_f32 v6, v74, v75
  v_cvt_pk_bf16_f32 v7, v76, v77
  v_cvt_pk_bf16_f32 v8, v78, v79
  v_cvt_pk_bf16_f32 v9, v80, v81
  buffer_store_dwordx4 v[2:5], v199, s[32:35], s47 offen offset:0 sc0 sc1
  buffer_store_dwordx4 v[6:9], v199, s[32:35], s47 offen offset:1024 sc0 sc1
  v_pk_mul_f32 v[82:83], v[82:83], v[18:19]
  v_pk_mul_f32 v[84:85], v[84:85], v[20:21]
  v_pk_mul_f32 v[86:87], v[86:87], v[22:23]
  v_pk_mul_f32 v[88:89], v[88:89], v[24:25]
  v_pk_mul_f32 v[90:91], v[90:91], v[26:27]
  v_pk_mul_f32 v[92:93], v[92:93], v[28:29]
  v_pk_mul_f32 v[94:95], v[94:95], v[30:31]
  v_pk_mul_f32 v[96:97], v[96:97], v[32:33]
  v_cvt_pk_bf16_f32 v18, v82, v83
  v_cvt_pk_bf16_f32 v19, v84, v85
  v_cvt_pk_bf16_f32 v20, v86, v87
  v_cvt_pk_bf16_f32 v21, v88, v89
  v_cvt_pk_bf16_f32 v22, v90, v91
  v_cvt_pk_bf16_f32 v23, v92, v93
  v_cvt_pk_bf16_f32 v24, v94, v95
  v_cvt_pk_bf16_f32 v25, v96, v97
  buffer_store_dwordx4 v[18:21], v199, s[32:35], s48 offen offset:0 sc0 sc1
  buffer_store_dwordx4 v[22:25], v199, s[32:35], s48 offen offset:1024 sc0 sc1
  s_waitcnt lgkmcnt(0)
  v_readfirstlane_b32 s49, v214
  s_mov_b32 s47, 81920
  s_andn2_b32 s49, s49, s57
  s_cbranch_scc1 k2_fall
  v_rcp_f32 v208, v46
  s_nop 0
  v_mul_f32 v34, v34, v208
  v_mul_f32 v35, v35, v208
  v_mul_f32 v36, v36, v208
  v_mul_f32 v37, v37, v208
  v_mul_f32 v38, v38, v208
  v_mul_f32 v39, v39, v208
  v_mul_f32 v40, v40, v208
  v_mul_f32 v41, v41, v208
  v_mul_f32 v42, v42, v208
  v_mul_f32 v43, v43, v208
  v_mul_f32 v44, v44, v208
  v_mul_f32 v45, v45, v208
  v_cvt_pk_bf16_f32 v66, v34, v35
  v_cvt_pk_bf16_f32 v67, v36, v37
  v_cvt_pk_bf16_f32 v68, v38, v39
  v_cvt_pk_bf16_f32 v69, v40, v41
  v_cvt_pk_bf16_f32 v70, v42, v43
  v_cvt_pk_bf16_f32 v71, v44, v45
  buffer_store_dwordx4 v[66:69], v197, s[36:39], 0 offen sc0 sc1
  buffer_store_dwordx2 v[70:71], v198, s[36:39], 0 offen sc0 sc1
  v_rcp_f32 v208, v62
  s_nop 0
  v_mul_f32 v50, v50, v208
  v_mul_f32 v51, v51, v208
  v_mul_f32 v52, v52, v208
  v_mul_f32 v53, v53, v208
  v_mul_f32 v54, v54, v208
  v_mul_f32 v55, v55, v208
  v_mul_f32 v56, v56, v208
  v_mul_f32 v57, v57, v208
  v_mul_f32 v58, v58, v208
  v_mul_f32 v59, v59, v208
  v_mul_f32 v60, v60, v208
  v_mul_f32 v61, v61, v208
  v_cvt_pk_bf16_f32 v82, v50, v51
  v_cvt_pk_bf16_f32 v83, v52, v53
  v_cvt_pk_bf16_f32 v84, v54, v55
  v_cvt_pk_bf16_f32 v85, v56, v57
  v_cvt_pk_bf16_f32 v86, v58, v59
  v_cvt_pk_bf16_f32 v87, v60, v61
  buffer_store_dwordx4 v[82:85], v197, s[36:39], s47 offen sc0 sc1
  buffer_store_dwordx2 v[86:87], v198, s[36:39], s47 offen sc0 sc1
  s_nop 1
k2_tl:
  s_mul_i32 s32, s12, 240640
  s_add_u32 s32, s32, 16777216
  v_lshlrev_b32 v136, 4, v0
  s_lshl_b32 s37, s10, 10
  s_add_u32 s20, s4, s32
  s_addc_u32 s21, s5, 0
  s_mov_b32 s22, 240640
  s_mov_b32 s23, 0x20000
  s_and_b32 s38, s10, 1
  s_mul_i32 s32, s38, 5120
  v_lshl_add_u32 v141, v203, 4, s32
  v_add_u32 v142, 0x10000, v141
  v_add_u32 v143, 0x20000, v141
  s_mul_i32 s32, s38, 163840
  v_subrev_u32 v144, s32, v143
  v_add_u32 v144, 27648, v144
  s_mul_i32 s32, s10, 5120
  s_xor_b32 s33, s10, 1
  s_mul_i32 s33, s33, 5120
  s_add_u32 s32, s32, 81920
  s_add_u32 s33, s33, 81920
  v_lshl_add_u32 v139, v203, 4, s32
  v_lshl_add_u32 v140, v203, 4, s33
  s_lshr_b32 s32, s11, 2
  s_lshl_b32 s32, s32, 5
  v_add_u32 v146, s32, v203
  v_min_u32 v147, 38, v203
  v_cmp_gt_u32 vcc, 32, v203
  v_lshl_add_u32 v147, v147, 5, s11
  v_subrev_u32 v147, 1024, v147
  v_cndmask_b32 v138, v147, v146, vcc
  v_lshlrev_b32 v138, 7, v138
  v_add_u32 v138, 18743296, v138
  s_lshl_b32 s32, s12, 5
  s_add_u32 s32, s32, s11
  s_lshl_b32 s32, s32, 7
  s_add_u32 s32, s32, 18743296
  v_mov_b32 v150, s32
  v_mov_b32 v151, 1
  v_and_b32 v146, 15, v0
  v_bfe_u32 v147, v0, 4, 2
  v_bfe_u32 v148, v0, 6, 1
  v_lshl_add_u32 v148, v148, 4, v146
  v_lshlrev_b32 v148, 4, v148
  v_lshl_add_u32 v148, v147, 9, v148
  v_lshl_add_u32 v148, s38, 11, v148
  s_mul_i32 s38, s38, 2146435072
  s_lshr_b32 s33, s10, 1
  s_lshl_b32 s34, s11, 1
  s_add_u32 s33, s33, s34
  s_mul_i32 s34, s33, 81920
  v_add_u32 v132, s34, v148
  s_mul_i32 s34, s33, 55296
  s_add_u32 s34, s34, 8388608
  v_add_u32 v134, s34, v148
  v_xor_b32 v133, 256, v132
  v_xor_b32 v135, 256, v134
  s_lshl_b32 s33, s11, 2
  s_add_u32 s33, s33, s10
  s_mul_i32 s33, s33, 20480
  s_mul_i32 s34, s12, 160
  s_add_u32 s33, s33, s34
  v_mul_u32_u24 v146, 1280, v146
  v_mul_u32_u24 v147, 40, v147
  v_add3_u32 v137, v146, v147, s33
  s_mov_b32 s16, s4
  s_mov_b32 s17, s5
  s_mov_b32 s18, 27262976
  s_mov_b32 s19, 0x20000
  s_mov_b32 s24, s6
  s_mov_b32 s25, s7
  s_mov_b32 s26, 2621440
  s_mov_b32 s27, 0x20000
  s_mov_b32 s28, s8
  s_mov_b32 s29, s9
  s_mov_b32 s30, 2621440
  s_mov_b32 s31, 0x20000
  buffer_load_dwordx4 v[122:125], v137, s[24:27], 0 offen offset:0
  buffer_load_dwordx4 v[126:129], v137, s[24:27], 0 offen offset:16
  buffer_load_dwordx2 v[130:131], v137, s[24:27], 0 offen offset:32
  s_waitcnt vmcnt(3)
  s_barrier
  s_cmp_lg_u32 s10, 0
  s_cbranch_scc1 k2_nf
  s_mov_b64 exec, 1
  buffer_store_dword v151, v150, s[16:19], 0 offen sc0 sc1
  s_mov_b64 exec, -1
k2_nf:
  s_add_u32 m0, s37, 49152
  s_mov_b32 s36, 49152
  buffer_load_dwordx4 v136, s[20:23], s36 offen sc1 lds
  s_add_u32 m0, s37, 53248
  s_mov_b32 s36, 53248
  buffer_load_dwordx4 v136, s[20:23], s36 offen sc1 lds
  s_add_u32 m0, s37, 57344
  s_mov_b32 s36, 57344
  buffer_load_dwordx4 v136, s[20:23], s36 offen sc1 lds
  s_add_u32 m0, s37, 61440
  s_mov_b32 s36, 61440
  buffer_load_dwordx4 v136, s[20:23], s36 offen sc1 lds
  s_add_u32 m0, s37, 90112
  s_mov_b32 s36, 90112
  buffer_load_dwordx4 v136, s[20:23], s36 offen sc1 lds
  s_add_u32 m0, s37, 94208
  s_mov_b32 s36, 94208
  buffer_load_dwordx4 v136, s[20:23], s36 offen sc1 lds
  s_add_u32 m0, s37, 98304
  s_mov_b32 s36, 98304
  buffer_load_dwordx4 v136, s[20:23], s36 offen sc1 lds
  s_add_u32 m0, s37, 102400
  s_mov_b32 s36, 102400
  buffer_load_dwordx4 v136, s[20:23], s36 offen sc1 lds
  s_add_u32 m0, s37, 106496
  s_mov_b32 s36, 106496
  buffer_load_dwordx4 v136, s[20:23], s36 offen sc1 lds
  s_add_u32 m0, s37, 110592
  s_mov_b32 s36, 110592
  buffer_load_dwordx4 v136, s[20:23], s36 offen sc1 lds
  s_add_u32 m0, s37, 114688
  s_mov_b32 s36, 114688
  buffer_load_dwordx4 v136, s[20:23], s36 offen sc1 lds
  s_add_u32 m0, s37, 118784
  s_mov_b32 s36, 118784
  buffer_load_dwordx4 v136, s[20:23], s36 offen sc1 lds
  s_add_u32 m0, s37, 122880
  s_mov_b32 s36, 122880
  buffer_load_dwordx4 v136, s[20:23], s36 offen sc1 lds
  s_add_u32 m0, s37, 126976
  s_mov_b32 s36, 126976
  buffer_load_dwordx4 v136, s[20:23], s36 offen sc1 lds
  s_mov_b32 s34, 0
  s_cmp_lg_u32 s10, 0
  s_cbranch_scc1 k2_p1
k2_p0:
  buffer_load_dword v146, v138, s[16:19], 0 offen sc1
  s_add_u32 s34, s34, 0x2000
  s_cbranch_scc1 k2_p1
  s_waitcnt vmcnt(0)
  v_cmp_ne_u32 vcc, 1, v146
  s_nop 1
  s_cbranch_vccnz k2_p0
k2_p1:
  s_waitcnt vmcnt(0) lgkmcnt(0)
  s_barrier
  s_mov_b32 s35, 0
  buffer_load_dwordx4 a[0:3], v134, s[16:19], s35 offen sc1
  ds_read_b128 v[82:85], v141 offset:0
  v_lshlrev_b32 v166, 16, v122
  v_and_b32 v167, 0xffff0000, v122
  buffer_load_dwordx4 a[4:7], v135, s[16:19], s35 offen sc1
  ds_read_b128 v[86:89], v141 offset:1024
  v_lshlrev_b32 v168, 16, v123
  v_and_b32 v169, 0xffff0000, v123
  s_mov_b32 s35, 4096
  buffer_load_dwordx4 a[8:11], v134, s[16:19], s35 offen sc1
  ds_read_b128 v[90:93], v141 offset:2048
  v_lshlrev_b32 v170, 16, v124
  v_and_b32 v171, 0xffff0000, v124
  buffer_load_dwordx4 a[12:15], v135, s[16:19], s35 offen sc1
  ds_read_b128 v[94:97], v141 offset:3072
  v_lshlrev_b32 v172, 16, v125
  v_and_b32 v173, 0xffff0000, v125
  s_mov_b32 s35, 8192
  buffer_load_dwordx4 a[16:19], v134, s[16:19], s35 offen sc1
  ds_read_b128 v[98:101], v141 offset:4096
  v_lshlrev_b32 v174, 16, v126
  v_and_b32 v175, 0xffff0000, v126
  buffer_load_dwordx4 a[20:23], v135, s[16:19], s35 offen sc1
  ds_read_b128 v[102:105], v141 offset:10240
  v_lshlrev_b32 v176, 16, v127
  v_and_b32 v177, 0xffff0000, v127
  s_mov_b32 s35, 12288
  buffer_load_dwordx4 a[24:27], v134, s[16:19], s35 offen sc1
  v_lshlrev_b32 v178, 16, v128
  v_and_b32 v179, 0xffff0000, v128
  buffer_load_dwordx4 a[28:31], v135, s[16:19], s35 offen sc1
  v_lshlrev_b32 v180, 16, v129
  v_and_b32 v181, 0xffff0000, v129
  s_mov_b32 s35, 16384
  buffer_load_dwordx4 a[32:35], v134, s[16:19], s35 offen sc1
  v_lshlrev_b32 v182, 16, v130
  v_and_b32 v183, 0xffff0000, v130
  buffer_load_dwordx4 a[36:39], v135, s[16:19], s35 offen sc1
  v_lshlrev_b32 v184, 16, v131
  v_and_b32 v185, 0xffff0000, v131
  s_mov_b32 s35, 20480
  buffer_load_dwordx4 a[40:43], v134, s[16:19], s35 offen sc1
  buffer_load_dwordx4 a[44:47], v135, s[16:19], s35 offen sc1
  s_mov_b32 s32, 0xbfb8aa3b
  s_mov_b32 s33, 0xffff0000
  s_waitcnt vmcnt(10) lgkmcnt(4)
  v_mfma_f32_16x16x32_bf16 v[42:45], v[82:85], a[0:3], 0
  ds_read_b128 v[106:109], v141 offset:11264
  v_mfma_f32_16x16x32_bf16 v[62:65], v[82:85], a[4:7], 0
  v_mfma_f32_16x16x32_bf16 v[46:49], v[86:89], a[0:3], 0
  ds_read_b128 v[110:113], v141 offset:12288
  v_mfma_f32_16x16x32_bf16 v[66:69], v[86:89], a[4:7], 0
  s_mov_b32 s35, 24576
  buffer_load_dwordx4 a[48:51], v134, s[16:19], s35 offen sc1
  s_waitcnt lgkmcnt(4)
  v_mfma_f32_16x16x32_bf16 v[50:53], v[90:93], a[0:3], 0
  ds_read_b128 v[114:117], v141 offset:13312
  v_mfma_f32_16x16x32_bf16 v[70:73], v[90:93], a[4:7], 0
  v_mfma_f32_16x16x32_bf16 v[54:57], v[94:97], a[0:3], 0
  ds_read_b128 v[118:121], v141 offset:14336
  buffer_load_dwordx4 a[52:55], v135, s[16:19], s35 offen sc1
  v_mfma_f32_16x16x32_bf16 v[74:77], v[94:97], a[4:7], 0
  s_waitcnt lgkmcnt(4)
  v_mfma_f32_16x16x32_bf16 v[58:61], v[98:101], a[0:3], 0
  ds_read_b128 v[82:85], v141 offset:20480
  v_mfma_f32_16x16x32_bf16 v[78:81], v[98:101], a[4:7], 0
  s_waitcnt vmcnt(10)
  v_mfma_f32_16x16x32_bf16 v[42:45], v[102:105], a[8:11], v[42:45]
  ds_read_b128 v[86:89], v141 offset:21504
  s_mov_b32 s35, 28672
  buffer_load_dwordx4 a[56:59], v134, s[16:19], s35 offen sc1
  v_mfma_f32_16x16x32_bf16 v[62:65], v[102:105], a[12:15], v[62:65]
  s_waitcnt lgkmcnt(4)
  v_mfma_f32_16x16x32_bf16 v[46:49], v[106:109], a[8:11], v[46:49]
  ds_read_b128 v[90:93], v141 offset:22528
  v_mfma_f32_16x16x32_bf16 v[66:69], v[106:109], a[12:15], v[66:69]
  buffer_load_dwordx4 a[60:63], v135, s[16:19], s35 offen sc1
  v_mfma_f32_16x16x32_bf16 v[50:53], v[110:113], a[8:11], v[50:53]
  ds_read_b128 v[94:97], v141 offset:23552
  v_mfma_f32_16x16x32_bf16 v[70:73], v[110:113], a[12:15], v[70:73]
  s_waitcnt lgkmcnt(4)
  v_mfma_f32_16x16x32_bf16 v[54:57], v[114:117], a[8:11], v[54:57]
  ds_read_b128 v[98:101], v141 offset:24576
  v_mfma_f32_16x16x32_bf16 v[74:77], v[114:117], a[12:15], v[74:77]
  s_mov_b32 s35, 32768
  buffer_load_dwordx4 a[64:67], v134, s[16:19], s35 offen sc1
  v_mfma_f32_16x16x32_bf16 v[58:61], v[118:121], a[8:11], v[58:61]
  ds_read_b128 v[102:105], v141 offset:30720
  v_mfma_f32_16x16x32_bf16 v[78:81], v[118:121], a[12:15], v[78:81]
  s_waitcnt vmcnt(11) lgkmcnt(4)
  v_mfma_f32_16x16x32_bf16 v[42:45], v[82:85], a[16:19], v[42:45]
  ds_read_b128 v[106:109], v141 offset:31744
  buffer_load_dwordx4 a[68:71], v135, s[16:19], s35 offen sc1
  v_mfma_f32_16x16x32_bf16 v[62:65], v[82:85], a[20:23], v[62:65]
  v_mfma_f32_16x16x32_bf16 v[46:49], v[86:89], a[16:19], v[46:49]
  ds_read_b128 v[110:113], v141 offset:32768
  v_mfma_f32_16x16x32_bf16 v[66:69], v[86:89], a[20:23], v[66:69]
  s_waitcnt lgkmcnt(4)
  v_mfma_f32_16x16x32_bf16 v[50:53], v[90:93], a[16:19], v[50:53]
  ds_read_b128 v[114:117], v141 offset:33792
  s_mov_b32 s35, 36864
  buffer_load_dwordx4 a[72:75], v134, s[16:19], s35 offen sc1
  v_mfma_f32_16x16x32_bf16 v[70:73], v[90:93], a[20:23], v[70:73]
  v_mfma_f32_16x16x32_bf16 v[54:57], v[94:97], a[16:19], v[54:57]
  ds_read_b128 v[118:121], v141 offset:34816
  v_mfma_f32_16x16x32_bf16 v[74:77], v[94:97], a[20:23], v[74:77]
  buffer_load_dwordx4 a[76:79], v135, s[16:19], s35 offen sc1
  s_waitcnt lgkmcnt(4)
  v_mfma_f32_16x16x32_bf16 v[58:61], v[98:101], a[16:19], v[58:61]
  ds_read_b128 v[82:85], v141 offset:40960
  v_mfma_f32_16x16x32_bf16 v[78:81], v[98:101], a[20:23], v[78:81]
  s_waitcnt vmcnt(12)
  v_mfma_f32_16x16x32_bf16 v[42:45], v[102:105], a[24:27], v[42:45]
  ds_read_b128 v[86:89], v141 offset:41984
  v_mfma_f32_16x16x32_bf16 v[62:65], v[102:105], a[28:31], v[62:65]
  s_mov_b32 s35, 40960
  buffer_load_dwordx4 a[80:83], v134, s[16:19], s35 offen sc1
  s_waitcnt lgkmcnt(4)
  v_mfma_f32_16x16x32_bf16 v[46:49], v[106:109], a[24:27], v[46:49]
  ds_read_b128 v[90:93], v141 offset:43008
  v_mfma_f32_16x16x32_bf16 v[66:69], v[106:109], a[28:31], v[66:69]
  v_mfma_f32_16x16x32_bf16 v[50:53], v[110:113], a[24:27], v[50:53]
  ds_read_b128 v[94:97], v141 offset:44032
  buffer_load_dwordx4 a[84:87], v135, s[16:19], s35 offen sc1
  v_mfma_f32_16x16x32_bf16 v[70:73], v[110:113], a[28:31], v[70:73]
  s_waitcnt lgkmcnt(4)
  v_mfma_f32_16x16x32_bf16 v[54:57], v[114:117], a[24:27], v[54:57]
  ds_read_b128 v[98:101], v141 offset:45056
  v_mfma_f32_16x16x32_bf16 v[74:77], v[114:117], a[28:31], v[74:77]
  v_mfma_f32_16x16x32_bf16 v[58:61], v[118:121], a[24:27], v[58:61]
  ds_read_b128 v[102:105], v141 offset:51200
  s_mov_b32 s35, 45056
  buffer_load_dwordx4 a[88:91], v134, s[16:19], s35 offen sc1
  v_mfma_f32_16x16x32_bf16 v[78:81], v[118:121], a[28:31], v[78:81]
  s_waitcnt vmcnt(13) lgkmcnt(4)
  s_barrier
  v_mfma_f32_16x16x32_bf16 v[42:45], v[82:85], a[32:35], v[42:45]
  ds_read_b128 v[106:109], v141 offset:52224
  v_mfma_f32_16x16x32_bf16 v[62:65], v[82:85], a[36:39], v[62:65]
  buffer_load_dwordx4 a[92:95], v135, s[16:19], s35 offen sc1
  v_mfma_f32_16x16x32_bf16 v[46:49], v[86:89], a[32:35], v[46:49]
  ds_read_b128 v[110:113], v141 offset:53248
  v_mfma_f32_16x16x32_bf16 v[66:69], v[86:89], a[36:39], v[66:69]
  s_waitcnt lgkmcnt(4)
  v_mfma_f32_16x16x32_bf16 v[50:53], v[90:93], a[32:35], v[50:53]
  ds_read_b128 v[114:117], v141 offset:54272
  v_mfma_f32_16x16x32_bf16 v[70:73], v[90:93], a[36:39], v[70:73]
  s_mov_b32 s35, 49152
  buffer_load_dwordx4 a[96:99], v134, s[16:19], s35 offen sc1
  v_mfma_f32_16x16x32_bf16 v[54:57], v[94:97], a[32:35], v[54:57]
  ds_read_b128 v[118:121], v141 offset:55296
  v_mfma_f32_16x16x32_bf16 v[74:77], v[94:97], a[36:39], v[74:77]
  s_waitcnt lgkmcnt(4)
  v_mfma_f32_16x16x32_bf16 v[58:61], v[98:101], a[32:35], v[58:61]
  ds_read_b128 v[82:85], v141 offset:61440
  buffer_load_dwordx4 a[100:103], v135, s[16:19], s35 offen sc1
  v_mfma_f32_16x16x32_bf16 v[78:81], v[98:101], a[36:39], v[78:81]
  s_waitcnt vmcnt(14)
  v_mfma_f32_16x16x32_bf16 v[42:45], v[102:105], a[40:43], v[42:45]
  ds_read_b128 v[86:89], v141 offset:62464
  v_mfma_f32_16x16x32_bf16 v[62:65], v[102:105], a[44:47], v[62:65]
  s_waitcnt lgkmcnt(4)
  v_mfma_f32_16x16x32_bf16 v[46:49], v[106:109], a[40:43], v[46:49]
  ds_read_b128 v[90:93], v141 offset:63488
  s_mov_b32 s35, 53248
  v_or_b32 v134, s38, v134
  buffer_load_dwordx4 a[104:107], v134, s[16:19], s35 offen sc1
  v_mfma_f32_16x16x32_bf16 v[66:69], v[106:109], a[44:47], v[66:69]
  v_mfma_f32_16x16x32_bf16 v[50:53], v[110:113], a[40:43], v[50:53]
  ds_read_b128 v[94:97], v141 offset:64512
  v_mfma_f32_16x16x32_bf16 v[70:73], v[110:113], a[44:47], v[70:73]
  v_or_b32 v135, s38, v135
  buffer_load_dwordx4 a[108:111], v135, s[16:19], s35 offen sc1
  s_waitcnt lgkmcnt(4)
  v_mfma_f32_16x16x32_bf16 v[54:57], v[114:117], a[40:43], v[54:57]
  ds_read_b128 v[98:101], v142 offset:0
  v_mfma_f32_16x16x32_bf16 v[74:77], v[114:117], a[44:47], v[74:77]
  v_mfma_f32_16x16x32_bf16 v[58:61], v[118:121], a[40:43], v[58:61]
  ds_read_b128 v[102:105], v142 offset:6144
  v_mfma_f32_16x16x32_bf16 v[78:81], v[118:121], a[44:47], v[78:81]
  s_mov_b32 s35, 0
  buffer_load_dwordx4 a[112:115], v132, s[16:19], s35 offen sc1
  s_waitcnt vmcnt(15) lgkmcnt(4)
  v_mfma_f32_16x16x32_bf16 v[42:45], v[82:85], a[48:51], v[42:45]
  ds_read_b128 v[106:109], v142 offset:7168
  v_mfma_f32_16x16x32_bf16 v[62:65], v[82:85], a[52:55], v[62:65]
  v_mfma_f32_16x16x32_bf16 v[46:49], v[86:89], a[48:51], v[46:49]
  ds_read_b128 v[110:113], v142 offset:8192
  buffer_load_dwordx4 a[116:119], v133, s[16:19], s35 offen sc1
  v_mfma_f32_16x16x32_bf16 v[66:69], v[86:89], a[52:55], v[66:69]
  s_waitcnt lgkmcnt(4)
  v_mfma_f32_16x16x32_bf16 v[50:53], v[90:93], a[48:51], v[50:53]
  ds_read_b128 v[114:117], v142 offset:9216
  v_mfma_f32_16x16x32_bf16 v[70:73], v[90:93], a[52:55], v[70:73]
  v_mfma_f32_16x16x32_bf16 v[54:57], v[94:97], a[48:51], v[54:57]
  ds_read_b128 v[118:121], v142 offset:10240
  s_add_u32 m0, s37, 0
  s_mov_b32 s36, 163840
  buffer_load_dwordx4 v136, s[20:23], s36 offen sc1 lds
  v_mfma_f32_16x16x32_bf16 v[74:77], v[94:97], a[52:55], v[74:77]
  s_waitcnt lgkmcnt(4)
  v_mfma_f32_16x16x32_bf16 v[58:61], v[98:101], a[48:51], v[58:61]
  ds_read_b128 v[82:85], v142 offset:16384
  v_mfma_f32_16x16x32_bf16 v[78:81], v[98:101], a[52:55], v[78:81]
  s_add_u32 m0, s37, 4096
  s_mov_b32 s36, 167936
  buffer_load_dwordx4 v136, s[20:23], s36 offen sc1 lds
  s_waitcnt vmcnt(16)
  v_mfma_f32_16x16x32_bf16 v[42:45], v[102:105], a[56:59], v[42:45]
  ds_read_b128 v[86:89], v142 offset:17408
  v_mfma_f32_16x16x32_bf16 v[62:65], v[102:105], a[60:63], v[62:65]
  s_waitcnt lgkmcnt(4)
  v_mfma_f32_16x16x32_bf16 v[46:49], v[106:109], a[56:59], v[46:49]
  ds_read_b128 v[90:93], v142 offset:18432
  v_mfma_f32_16x16x32_bf16 v[66:69], v[106:109], a[60:63], v[66:69]
  s_add_u32 m0, s37, 8192
  s_mov_b32 s36, 172032
  buffer_load_dwordx4 v136, s[20:23], s36 offen sc1 lds
  v_mfma_f32_16x16x32_bf16 v[50:53], v[110:113], a[56:59], v[50:53]
  ds_read_b128 v[94:97], v142 offset:19456
  v_mfma_f32_16x16x32_bf16 v[70:73], v[110:113], a[60:63], v[70:73]
  s_waitcnt lgkmcnt(4)
  v_mfma_f32_16x16x32_bf16 v[54:57], v[114:117], a[56:59], v[54:57]
  ds_read_b128 v[98:101], v142 offset:20480
  s_add_u32 m0, s37, 12288
  s_mov_b32 s36, 176128
  buffer_load_dwordx4 v136, s[20:23], s36 offen sc1 lds
  v_mfma_f32_16x16x32_bf16 v[74:77], v[114:117], a[60:63], v[74:77]
  v_mfma_f32_16x16x32_bf16 v[58:61], v[118:121], a[56:59], v[58:61]
  ds_read_b128 v[102:105], v142 offset:26624
  v_mfma_f32_16x16x32_bf16 v[78:81], v[118:121], a[60:63], v[78:81]
  s_waitcnt vmcnt(16) lgkmcnt(4)
  v_mfma_f32_16x16x32_bf16 v[42:45], v[82:85], a[64:67], v[42:45]
  ds_read_b128 v[106:109], v142 offset:27648
  s_add_u32 m0, s37, 16384
  s_mov_b32 s36, 180224
  buffer_load_dwordx4 v136, s[20:23], s36 offen sc1 lds
  v_mfma_f32_16x16x32_bf16 v[62:65], v[82:85], a[68:71], v[62:65]
  v_mfma_f32_16x16x32_bf16 v[46:49], v[86:89], a[64:67], v[46:49]
  ds_read_b128 v[110:113], v142 offset:28672
  v_mfma_f32_16x16x32_bf16 v[66:69], v[86:89], a[68:71], v[66:69]
  s_mov_b32 s35, 4096
  buffer_load_dwordx4 a[120:123], v132, s[16:19], s35 offen sc1
  s_waitcnt lgkmcnt(4)
  v_mfma_f32_16x16x32_bf16 v[50:53], v[90:93], a[64:67], v[50:53]
  ds_read_b128 v[114:117], v142 offset:29696
  v_mfma_f32_16x16x32_bf16 v[70:73], v[90:93], a[68:71], v[70:73]
  v_mfma_f32_16x16x32_bf16 v[54:57], v[94:97], a[64:67], v[54:57]
  ds_read_b128 v[118:121], v142 offset:30720
  v_mfma_f32_16x16x32_bf16 v[74:77], v[94:97], a[68:71], v[74:77]
  buffer_load_dwordx4 a[124:127], v133, s[16:19], s35 offen sc1
  s_waitcnt lgkmcnt(4)
  v_mfma_f32_16x16x32_bf16 v[58:61], v[98:101], a[64:67], v[58:61]
  ds_read_b128 v[82:85], v142 offset:36864
  v_mfma_f32_16x16x32_bf16 v[78:81], v[98:101], a[68:71], v[78:81]
  s_waitcnt vmcnt(17)
  v_mfma_f32_16x16x32_bf16 v[42:45], v[102:105], a[72:75], v[42:45]
  ds_read_b128 v[86:89], v142 offset:37888
  s_mov_b32 s35, 8192
  buffer_load_dwordx4 a[128:131], v132, s[16:19], s35 offen sc1
  v_mfma_f32_16x16x32_bf16 v[62:65], v[102:105], a[76:79], v[62:65]
  s_waitcnt lgkmcnt(4)
  v_mfma_f32_16x16x32_bf16 v[46:49], v[106:109], a[72:75], v[46:49]
  ds_read_b128 v[90:93], v142 offset:38912
  v_mfma_f32_16x16x32_bf16 v[66:69], v[106:109], a[76:79], v[66:69]
  v_mfma_f32_16x16x32_bf16 v[50:53], v[110:113], a[72:75], v[50:53]
  ds_read_b128 v[94:97], v142 offset:39936
  buffer_load_dwordx4 a[132:135], v133, s[16:19], s35 offen sc1
  v_mfma_f32_16x16x32_bf16 v[70:73], v[110:113], a[76:79], v[70:73]
  s_waitcnt lgkmcnt(4)
  v_mfma_f32_16x16x32_bf16 v[54:57], v[114:117], a[72:75], v[54:57]
  ds_read_b128 v[98:101], v142 offset:40960
  v_mfma_f32_16x16x32_bf16 v[74:77], v[114:117], a[76:79], v[74:77]
  s_add_u32 m0, s37, 20480
  s_mov_b32 s36, 184320
  buffer_load_dwordx4 v136, s[20:23], s36 offen sc1 lds
  v_mfma_f32_16x16x32_bf16 v[58:61], v[118:121], a[72:75], v[58:61]
  ds_read_b128 v[102:105], v142 offset:47104
  v_mfma_f32_16x16x32_bf16 v[78:81], v[118:121], a[76:79], v[78:81]
  s_waitcnt vmcnt(18) lgkmcnt(4)
  s_barrier
  v_mfma_f32_16x16x32_bf16 v[42:45], v[82:85], a[80:83], v[42:45]
  ds_read_b128 v[106:109], v142 offset:48128
  v_mfma_f32_16x16x32_bf16 v[62:65], v[82:85], a[84:87], v[62:65]
  s_add_u32 m0, s37, 24576
  s_mov_b32 s36, 188416
  buffer_load_dwordx4 v136, s[20:23], s36 offen sc1 lds
  v_mfma_f32_16x16x32_bf16 v[46:49], v[86:89], a[80:83], v[46:49]
  ds_read_b128 v[110:113], v142 offset:49152
  v_mfma_f32_16x16x32_bf16 v[66:69], v[86:89], a[84:87], v[66:69]
  s_waitcnt lgkmcnt(4)
  v_mfma_f32_16x16x32_bf16 v[50:53], v[90:93], a[80:83], v[50:53]
  ds_read_b128 v[114:117], v142 offset:50176
  s_add_u32 m0, s37, 28672
  s_mov_b32 s36, 192512
  buffer_load_dwordx4 v136, s[20:23], s36 offen sc1 lds
  v_mfma_f32_16x16x32_bf16 v[70:73], v[90:93], a[84:87], v[70:73]
  v_mfma_f32_16x16x32_bf16 v[54:57], v[94:97], a[80:83], v[54:57]
  ds_read_b128 v[118:121], v142 offset:51200
  v_mfma_f32_16x16x32_bf16 v[74:77], v[94:97], a[84:87], v[74:77]
  s_waitcnt lgkmcnt(4)
  v_mfma_f32_16x16x32_bf16 v[58:61], v[98:101], a[80:83], v[58:61]
  ds_read_b128 v[82:85], v142 offset:57344
  s_add_u32 m0, s37, 32768
  s_mov_b32 s36, 196608
  buffer_load_dwordx4 v136, s[20:23], s36 offen sc1 lds
  v_mfma_f32_16x16x32_bf16 v[78:81], v[98:101], a[84:87], v[78:81]
  s_waitcnt vmcnt(19)
  v_mfma_f32_16x16x32_bf16 v[42:45], v[102:105], a[88:91], v[42:45]
  ds_read_b128 v[86:89], v142 offset:58368
  v_mfma_f32_16x16x32_bf16 v[62:65], v[102:105], a[92:95], v[62:65]
  s_add_u32 m0, s37, 36864
  s_mov_b32 s36, 200704
  buffer_load_dwordx4 v136, s[20:23], s36 offen sc1 lds
  s_waitcnt lgkmcnt(4)
  v_mfma_f32_16x16x32_bf16 v[46:49], v[106:109], a[88:91], v[46:49]
  ds_read_b128 v[90:93], v142 offset:59392
  v_mfma_f32_16x16x32_bf16 v[66:69], v[106:109], a[92:95], v[66:69]
  v_mfma_f32_16x16x32_bf16 v[50:53], v[110:113], a[88:91], v[50:53]
  ds_read_b128 v[94:97], v142 offset:60416
  v_mfma_f32_16x16x32_bf16 v[70:73], v[110:113], a[92:95], v[70:73]
  s_mov_b32 s35, 12288
  buffer_load_dwordx4 a[136:139], v132, s[16:19], s35 offen sc1
  s_waitcnt lgkmcnt(4)
  v_mfma_f32_16x16x32_bf16 v[54:57], v[114:117], a[88:91], v[54:57]
  ds_read_b128 v[98:101], v142 offset:61440
  v_mfma_f32_16x16x32_bf16 v[74:77], v[114:117], a[92:95], v[74:77]
  v_mfma_f32_16x16x32_bf16 v[58:61], v[118:121], a[88:91], v[58:61]
  ds_read_b128 v[102:105], v143 offset:2048
  buffer_load_dwordx4 a[140:143], v133, s[16:19], s35 offen sc1
  v_mfma_f32_16x16x32_bf16 v[78:81], v[118:121], a[92:95], v[78:81]
  s_waitcnt vmcnt(20) lgkmcnt(4)
  v_mfma_f32_16x16x32_bf16 v[42:45], v[82:85], a[96:99], v[42:45]
  ds_read_b128 v[106:109], v143 offset:3072
  v_mfma_f32_16x16x32_bf16 v[62:65], v[82:85], a[100:103], v[62:65]
  v_mfma_f32_16x16x32_bf16 v[46:49], v[86:89], a[96:99], v[46:49]
  ds_read_b128 v[110:113], v143 offset:4096
  s_mov_b32 s35, 16384
  buffer_load_dwordx4 a[144:147], v132, s[16:19], s35 offen sc1
  v_mfma_f32_16x16x32_bf16 v[66:69], v[86:89], a[100:103], v[66:69]
  s_waitcnt lgkmcnt(4)
  v_mfma_f32_16x16x32_bf16 v[50:53], v[90:93], a[96:99], v[50:53]
  ds_read_b128 v[114:117], v143 offset:5120
  v_mfma_f32_16x16x32_bf16 v[70:73], v[90:93], a[100:103], v[70:73]
  buffer_load_dwordx4 a[148:151], v133, s[16:19], s35 offen sc1
  v_mfma_f32_16x16x32_bf16 v[54:57], v[94:97], a[96:99], v[54:57]
  ds_read_b128 v[118:121], v143 offset:6144
  v_mfma_f32_16x16x32_bf16 v[74:77], v[94:97], a[100:103], v[74:77]
  s_waitcnt lgkmcnt(4)
  v_mfma_f32_16x16x32_bf16 v[58:61], v[98:101], a[96:99], v[58:61]
  ds_read_b128 v[82:85], v143 offset:7168
  v_mfma_f32_16x16x32_bf16 v[78:81], v[98:101], a[100:103], v[78:81]
  s_add_u32 m0, s37, 40960
  s_mov_b32 s36, 204800
  buffer_load_dwordx4 v136, s[20:23], s36 offen sc1 lds
  s_waitcnt vmcnt(21) lgkmcnt(4)
  v_mfma_f32_16x16x32_bf16 v[62:65], v[102:105], a[108:111], v[62:65]
  ds_read_b128 v[86:89], v143 offset:8192
  s_waitcnt lgkmcnt(4)
  v_mfma_f32_16x16x32_bf16 v[66:69], v[106:109], a[108:111], v[66:69]
  s_waitcnt lgkmcnt(3)
  v_mfma_f32_16x16x32_bf16 v[70:73], v[110:113], a[108:111], v[70:73]
  ds_read_b128 v[90:93], v143 offset:9216
  s_add_u32 m0, s37, 45056
  s_mov_b32 s36, 208896
  buffer_load_dwordx4 v136, s[20:23], s36 offen sc1 lds
  s_waitcnt lgkmcnt(3)
  v_mfma_f32_16x16x32_bf16 v[74:77], v[114:117], a[108:111], v[74:77]
  s_waitcnt lgkmcnt(2)
  v_mfma_f32_16x16x32_bf16 v[78:81], v[118:121], a[108:111], v[78:81]
  ds_read_b128 v[94:97], v143 offset:10240
  v_mfma_f32_16x16x32_bf16 v[42:45], v[102:105], a[104:107], v[42:45]
  v_mfma_f32_16x16x32_bf16 v[46:49], v[106:109], a[104:107], v[46:49]
  ds_read_b128 v[98:101], v143 offset:11264
  s_add_u32 m0, s37, 49152
  s_mov_b32 s36, 212992
  buffer_load_dwordx4 v136, s[20:23], s36 offen sc1 lds
  v_mfma_f32_16x16x32_bf16 v[50:53], v[110:113], a[104:107], v[50:53]
  ds_write_b128 v139, v[62:65] offset:0
  v_mfma_f32_16x16x32_bf16 v[54:57], v[114:117], a[104:107], v[54:57]
  ds_read_b128 v[102:105], v143 offset:17408
  v_mfma_f32_16x16x32_bf16 v[58:61], v[118:121], a[104:107], v[58:61]
  ds_write_b128 v139, v[66:69] offset:1024
  s_add_u32 m0, s37, 53248
  s_mov_b32 s36, 217088
  buffer_load_dwordx4 v136, s[20:23], s36 offen sc1 lds
  s_waitcnt vmcnt(22) lgkmcnt(6)
  v_mfma_f32_16x16x32_bf16 v[2:5], v[82:85], a[112:115], 0
  ds_read_b128 v[106:109], v143 offset:18432
  v_mfma_f32_16x16x32_bf16 v[22:25], v[82:85], a[116:119], 0
  ds_write_b128 v139, v[70:73] offset:2048
  v_mfma_f32_16x16x32_bf16 v[6:9], v[86:89], a[112:115], 0
  ds_read_b128 v[110:113], v143 offset:19456
  v_mfma_f32_16x16x32_bf16 v[26:29], v[86:89], a[116:119], 0
  ds_write_b128 v139, v[74:77] offset:3072
  s_add_u32 m0, s37, 57344
  s_mov_b32 s36, 221184
  buffer_load_dwordx4 v136, s[20:23], s36 offen sc1 lds
  s_waitcnt lgkmcnt(8)
  v_mfma_f32_16x16x32_bf16 v[10:13], v[90:93], a[112:115], 0
  ds_read_b128 v[114:117], v143 offset:20480
  v_mfma_f32_16x16x32_bf16 v[30:33], v[90:93], a[116:119], 0
  ds_write_b128 v139, v[78:81] offset:4096
  v_mfma_f32_16x16x32_bf16 v[14:17], v[94:97], a[112:115], 0
  ds_read_b128 v[118:121], v143 offset:21504
  s_mov_b32 s35, 20480
  buffer_load_dwordx4 a[152:155], v132, s[16:19], s35 offen sc1
  v_mfma_f32_16x16x32_bf16 v[34:37], v[94:97], a[116:119], 0
  s_waitcnt vmcnt(19) lgkmcnt(1)
  s_barrier
  v_mfma_f32_16x16x32_bf16 v[18:21], v[98:101], a[112:115], 0
  ds_read_b128 v[82:85], v144 offset:0
  ds_read_b128 v[62:65], v140 offset:0
  v_mfma_f32_16x16x32_bf16 v[38:41], v[98:101], a[116:119], 0
  ds_read_b128 v[66:69], v140 offset:1024
  s_waitcnt vmcnt(17)
  v_mfma_f32_16x16x32_bf16 v[2:5], v[102:105], a[120:123], v[2:5]
  ds_read_b128 v[86:89], v144 offset:1024
  ds_read_b128 v[70:73], v140 offset:2048
  buffer_load_dwordx4 a[156:159], v133, s[16:19], s35 offen sc1
  v_mfma_f32_16x16x32_bf16 v[22:25], v[102:105], a[124:127], v[22:25]
  ds_read_b128 v[74:77], v140 offset:3072
  v_mfma_f32_16x16x32_bf16 v[6:9], v[106:109], a[120:123], v[6:9]
  ds_read_b128 v[90:93], v144 offset:2048
  ds_read_b128 v[78:81], v140 offset:4096
  v_mfma_f32_16x16x32_bf16 v[26:29], v[106:109], a[124:127], v[26:29]
  s_mov_b32 s35, 24576
  buffer_load_dwordx4 a[160:163], v132, s[16:19], s35 offen sc1
  v_mfma_f32_16x16x32_bf16 v[10:13], v[110:113], a[120:123], v[10:13]
  ds_read_b128 v[94:97], v144 offset:3072
  v_mfma_f32_16x16x32_bf16 v[30:33], v[110:113], a[124:127], v[30:33]
  s_waitcnt lgkmcnt(9)
  v_mfma_f32_16x16x32_bf16 v[14:17], v[114:117], a[120:123], v[14:17]
  ds_read_b128 v[98:101], v144 offset:4096
  v_mfma_f32_16x16x32_bf16 v[34:37], v[114:117], a[124:127], v[34:37]
  buffer_load_dwordx4 a[164:167], v133, s[16:19], s35 offen sc1
  s_waitcnt lgkmcnt(2)
  v_mfma_f32_16x16x32_bf16 v[18:21], v[118:121], a[120:123], v[18:21]
  ds_read_b128 v[102:105], v141 offset:5120
  v_add_f32 v42, v42, v62
  v_add_f32 v43, v43, v63
  v_mfma_f32_16x16x32_bf16 v[38:41], v[118:121], a[124:127], v[38:41]
  v_add_f32 v44, v44, v64
  v_add_f32 v45, v45, v65
  s_waitcnt vmcnt(18)
  v_mfma_f32_16x16x32_bf16 v[2:5], v[82:85], a[128:131], v[2:5]
  ds_read_b128 v[106:109], v141 offset:6144
  s_add_u32 m0, s37, 61440
  s_mov_b32 s36, 225280
  buffer_load_dwordx4 v136, s[20:23], s36 offen sc1 lds
  v_mfma_f32_16x16x32_bf16 v[22:25], v[82:85], a[132:135], v[22:25]
  v_mul_f32 v146, s32, v42
  v_mul_f32 v147, s32, v43
  v_mul_f32 v148, s32, v44
  v_mfma_f32_16x16x32_bf16 v[6:9], v[86:89], a[128:131], v[6:9]
  ds_read_b128 v[110:113], v141 offset:7168
  v_mul_f32 v149, s32, v45
  v_mfma_f32_16x16x32_bf16 v[26:29], v[86:89], a[132:135], v[26:29]
  v_exp_f32 v146, v146
  s_waitcnt lgkmcnt(4)
  v_mfma_f32_16x16x32_bf16 v[10:13], v[90:93], a[128:131], v[10:13]
  ds_read_b128 v[114:117], v141 offset:8192
  s_add_u32 m0, s37, 65536
  s_mov_b32 s36, 229376
  buffer_load_dwordx4 v136, s[20:23], s36 offen sc1 lds
  v_mfma_f32_16x16x32_bf16 v[30:33], v[90:93], a[132:135], v[30:33]
  v_exp_f32 v147, v147
  v_mfma_f32_16x16x32_bf16 v[14:17], v[94:97], a[128:131], v[14:17]
  ds_read_b128 v[118:121], v141 offset:9216
  v_exp_f32 v148, v148
  v_mfma_f32_16x16x32_bf16 v[34:37], v[94:97], a[132:135], v[34:37]
  s_add_u32 m0, s37, 69632
  s_mov_b32 s36, 233472
  buffer_load_dwordx4 v136, s[20:23], s36 offen sc1 lds
  s_waitcnt vmcnt(16) lgkmcnt(4)
  s_barrier
  v_mfma_f32_16x16x32_bf16 v[18:21], v[98:101], a[128:131], v[18:21]
  ds_read_b128 v[82:85], v141 offset:15360
  v_exp_f32 v149, v149
  v_mfma_f32_16x16x32_bf16 v[38:41], v[98:101], a[132:135], v[38:41]
  v_add_f32 v146, 1.0, v146
  v_add_f32 v147, 1.0, v147
  v_add_f32 v148, 1.0, v148
  s_waitcnt vmcnt(14)
  v_mfma_f32_16x16x32_bf16 v[2:5], v[102:105], a[136:139], v[2:5]
  ds_read_b128 v[86:89], v141 offset:16384
  v_add_f32 v149, 1.0, v149
  v_mfma_f32_16x16x32_bf16 v[22:25], v[102:105], a[140:143], v[22:25]
  s_add_u32 m0, s37, 73728
  s_mov_b32 s36, 237568
  buffer_load_dwordx4 v136, s[20:23], s36 offen sc1 lds
  s_waitcnt lgkmcnt(4)
  v_mfma_f32_16x16x32_bf16 v[6:9], v[106:109], a[136:139], v[6:9]
  ds_read_b128 v[90:93], v141 offset:17408
  v_rcp_f32 v146, v146
  v_mfma_f32_16x16x32_bf16 v[26:29], v[106:109], a[140:143], v[26:29]
  v_rcp_f32 v147, v147
  v_mfma_f32_16x16x32_bf16 v[10:13], v[110:113], a[136:139], v[10:13]
  ds_read_b128 v[94:97], v141 offset:18432
  s_mov_b32 s35, 28672
  buffer_load_dwordx4 a[168:171], v132, s[16:19], s35 offen sc1
  v_mfma_f32_16x16x32_bf16 v[30:33], v[110:113], a[140:143], v[30:33]
  v_rcp_f32 v148, v148
  s_waitcnt lgkmcnt(4)
  v_mfma_f32_16x16x32_bf16 v[14:17], v[114:117], a[136:139], v[14:17]
  ds_read_b128 v[98:101], v141 offset:19456
  v_rcp_f32 v149, v149
  v_mfma_f32_16x16x32_bf16 v[34:37], v[114:117], a[140:143], v[34:37]
  v_mul_f32 v42, v42, v146
  v_mul_f32 v43, v43, v147
  v_mul_f32 v44, v44, v148
  v_mfma_f32_16x16x32_bf16 v[18:21], v[118:121], a[136:139], v[18:21]
  ds_read_b128 v[102:105], v141 offset:25600
  buffer_load_dwordx4 a[172:175], v133, s[16:19], s35 offen sc1
  v_mul_f32 v45, v45, v149
  v_mfma_f32_16x16x32_bf16 v[38:41], v[118:121], a[140:143], v[38:41]
  v_add_f32 v46, v46, v66
  v_add_f32 v47, v47, v67
  s_waitcnt vmcnt(15) lgkmcnt(4)
  v_mfma_f32_16x16x32_bf16 v[2:5], v[82:85], a[144:147], v[2:5]
  ds_read_b128 v[106:109], v141 offset:26624
  v_add_f32 v48, v48, v68
  v_add_f32 v49, v49, v69
  v_mfma_f32_16x16x32_bf16 v[22:25], v[82:85], a[148:151], v[22:25]
  s_mov_b32 s35, 32768
  buffer_load_dwordx4 a[176:179], v132, s[16:19], s35 offen sc1
  v_mul_f32 v150, s32, v46
  v_mfma_f32_16x16x32_bf16 v[6:9], v[86:89], a[144:147], v[6:9]
  ds_read_b128 v[110:113], v141 offset:27648
  v_mul_f32 v151, s32, v47
  v_mul_f32 v152, s32, v48
  v_mfma_f32_16x16x32_bf16 v[26:29], v[86:89], a[148:151], v[26:29]
  v_mul_f32 v153, s32, v49
  s_waitcnt lgkmcnt(4)
  v_mfma_f32_16x16x32_bf16 v[10:13], v[90:93], a[144:147], v[10:13]
  ds_read_b128 v[114:117], v141 offset:28672
  v_exp_f32 v150, v150
  v_mfma_f32_16x16x32_bf16 v[30:33], v[90:93], a[148:151], v[30:33]
  buffer_load_dwordx4 a[180:183], v133, s[16:19], s35 offen sc1
  v_exp_f32 v151, v151
  v_mfma_f32_16x16x32_bf16 v[14:17], v[94:97], a[144:147], v[14:17]
  ds_read_b128 v[118:121], v141 offset:29696
  v_exp_f32 v152, v152
  v_mfma_f32_16x16x32_bf16 v[34:37], v[94:97], a[148:151], v[34:37]
  v_exp_f32 v153, v153
  s_waitcnt vmcnt(12) lgkmcnt(4)
  s_barrier
  v_mfma_f32_16x16x32_bf16 v[18:21], v[98:101], a[144:147], v[18:21]
  ds_read_b128 v[82:85], v141 offset:35840
  s_mov_b32 s35, 36864
  buffer_load_dwordx4 a[184:187], v132, s[16:19], s35 offen sc1
  v_mfma_f32_16x16x32_bf16 v[38:41], v[98:101], a[148:151], v[38:41]
  v_add_f32 v150, 1.0, v150
  v_add_f32 v151, 1.0, v151
  v_add_f32 v152, 1.0, v152
  s_waitcnt vmcnt(11)
  v_mfma_f32_16x16x32_bf16 v[2:5], v[102:105], a[152:155], v[2:5]
  ds_read_b128 v[86:89], v141 offset:36864
  v_add_f32 v153, 1.0, v153
  v_mfma_f32_16x16x32_bf16 v[22:25], v[102:105], a[156:159], v[22:25]
  v_rcp_f32 v150, v150
  s_waitcnt lgkmcnt(4)
  v_mfma_f32_16x16x32_bf16 v[6:9], v[106:109], a[152:155], v[6:9]
  ds_read_b128 v[90:93], v141 offset:37888
  buffer_load_dwordx4 a[188:191], v133, s[16:19], s35 offen sc1
  v_mfma_f32_16x16x32_bf16 v[26:29], v[106:109], a[156:159], v[26:29]
  v_rcp_f32 v151, v151
  v_mfma_f32_16x16x32_bf16 v[10:13], v[110:113], a[152:155], v[10:13]
  ds_read_b128 v[94:97], v141 offset:38912
  v_rcp_f32 v152, v152
  v_mfma_f32_16x16x32_bf16 v[30:33], v[110:113], a[156:159], v[30:33]
  v_rcp_f32 v153, v153
  s_waitcnt lgkmcnt(4)
  v_mfma_f32_16x16x32_bf16 v[14:17], v[114:117], a[152:155], v[14:17]
  ds_read_b128 v[98:101], v141 offset:39936
  v_mul_f32 v46, v46, v150
  v_mul_f32 v47, v47, v151
  v_mfma_f32_16x16x32_bf16 v[34:37], v[114:117], a[156:159], v[34:37]
  v_mul_f32 v48, v48, v152
  v_mul_f32 v49, v49, v153
  v_add_f32 v50, v50, v70
  v_mfma_f32_16x16x32_bf16 v[18:21], v[118:121], a[152:155], v[18:21]
  ds_read_b128 v[102:105], v141 offset:46080
  v_add_f32 v51, v51, v71
  v_add_f32 v52, v52, v72
  v_mfma_f32_16x16x32_bf16 v[38:41], v[118:121], a[156:159], v[38:41]
  v_add_f32 v53, v53, v73
  v_mul_f32 v154, s32, v50
  s_waitcnt vmcnt(10) lgkmcnt(4)
  v_mfma_f32_16x16x32_bf16 v[2:5], v[82:85], a[160:163], v[2:5]
  ds_read_b128 v[106:109], v141 offset:47104
  v_mul_f32 v155, s32, v51
  v_mul_f32 v156, s32, v52
  v_mfma_f32_16x16x32_bf16 v[22:25], v[82:85], a[164:167], v[22:25]
  v_mul_f32 v157, s32, v53
  v_exp_f32 v154, v154
  v_mfma_f32_16x16x32_bf16 v[6:9], v[86:89], a[160:163], v[6:9]
  ds_read_b128 v[110:113], v141 offset:48128
  v_exp_f32 v155, v155
  v_mfma_f32_16x16x32_bf16 v[26:29], v[86:89], a[164:167], v[26:29]
  v_exp_f32 v156, v156
  s_waitcnt lgkmcnt(4)
  v_mfma_f32_16x16x32_bf16 v[10:13], v[90:93], a[160:163], v[10:13]
  ds_read_b128 v[114:117], v141 offset:49152
  v_exp_f32 v157, v157
  v_mfma_f32_16x16x32_bf16 v[30:33], v[90:93], a[164:167], v[30:33]
  v_add_f32 v154, 1.0, v154
  v_add_f32 v155, 1.0, v155
  v_add_f32 v156, 1.0, v156
  v_mfma_f32_16x16x32_bf16 v[14:17], v[94:97], a[160:163], v[14:17]
  ds_read_b128 v[118:121], v141 offset:50176
  v_add_f32 v157, 1.0, v157
  v_mfma_f32_16x16x32_bf16 v[34:37], v[94:97], a[164:167], v[34:37]
  v_rcp_f32 v154, v154
  s_waitcnt vmcnt(6) lgkmcnt(4)
  s_barrier
  v_mfma_f32_16x16x32_bf16 v[18:21], v[98:101], a[160:163], v[18:21]
  ds_read_b128 v[82:85], v141 offset:56320
  v_rcp_f32 v155, v155
  v_mfma_f32_16x16x32_bf16 v[38:41], v[98:101], a[164:167], v[38:41]
  v_rcp_f32 v156, v156
  s_waitcnt vmcnt(4)
  v_mfma_f32_16x16x32_bf16 v[2:5], v[102:105], a[168:171], v[2:5]
  ds_read_b128 v[86:89], v141 offset:57344
  v_rcp_f32 v157, v157
  v_mfma_f32_16x16x32_bf16 v[22:25], v[102:105], a[172:175], v[22:25]
  v_mul_f32 v50, v50, v154
  v_mul_f32 v51, v51, v155
  s_waitcnt lgkmcnt(4)
  v_mfma_f32_16x16x32_bf16 v[6:9], v[106:109], a[168:171], v[6:9]
  ds_read_b128 v[90:93], v141 offset:58368
  v_mul_f32 v52, v52, v156
  v_mul_f32 v53, v53, v157
  v_mfma_f32_16x16x32_bf16 v[26:29], v[106:109], a[172:175], v[26:29]
  v_add_f32 v54, v54, v74
  v_add_f32 v55, v55, v75
  v_add_f32 v56, v56, v76
  v_mfma_f32_16x16x32_bf16 v[10:13], v[110:113], a[168:171], v[10:13]
  ds_read_b128 v[94:97], v141 offset:59392
  v_add_f32 v57, v57, v77
  v_mul_f32 v158, s32, v54
  v_mfma_f32_16x16x32_bf16 v[30:33], v[110:113], a[172:175], v[30:33]
  v_mul_f32 v159, s32, v55
  v_mul_f32 v160, s32, v56
  s_waitcnt lgkmcnt(4)
  v_mfma_f32_16x16x32_bf16 v[14:17], v[114:117], a[168:171], v[14:17]
  ds_read_b128 v[98:101], v141 offset:60416
  v_mul_f32 v161, s32, v57
  v_mfma_f32_16x16x32_bf16 v[34:37], v[114:117], a[172:175], v[34:37]
  v_exp_f32 v158, v158
  v_mfma_f32_16x16x32_bf16 v[18:21], v[118:121], a[168:171], v[18:21]
  ds_read_b128 v[102:105], v142 offset:1024
  v_exp_f32 v159, v159
  v_mfma_f32_16x16x32_bf16 v[38:41], v[118:121], a[172:175], v[38:41]
  v_exp_f32 v160, v160
  s_waitcnt vmcnt(2) lgkmcnt(4)
  v_mfma_f32_16x16x32_bf16 v[2:5], v[82:85], a[176:179], v[2:5]
  ds_read_b128 v[106:109], v142 offset:2048
  v_exp_f32 v161, v161
  v_mfma_f32_16x16x32_bf16 v[22:25], v[82:85], a[180:183], v[22:25]
  v_add_f32 v158, 1.0, v158
  v_add_f32 v159, 1.0, v159
  v_add_f32 v160, 1.0, v160
  v_mfma_f32_16x16x32_bf16 v[6:9], v[86:89], a[176:179], v[6:9]
  ds_read_b128 v[110:113], v142 offset:3072
  v_add_f32 v161, 1.0, v161
  v_mfma_f32_16x16x32_bf16 v[26:29], v[86:89], a[180:183], v[26:29]
  v_rcp_f32 v158, v158
  s_waitcnt lgkmcnt(4)
  v_mfma_f32_16x16x32_bf16 v[10:13], v[90:93], a[176:179], v[10:13]
  ds_read_b128 v[114:117], v142 offset:4096
  v_rcp_f32 v159, v159
  v_mfma_f32_16x16x32_bf16 v[30:33], v[90:93], a[180:183], v[30:33]
  v_rcp_f32 v160, v160
  v_mfma_f32_16x16x32_bf16 v[14:17], v[94:97], a[176:179], v[14:17]
  ds_read_b128 v[118:121], v142 offset:5120
  v_rcp_f32 v161, v161
  v_mfma_f32_16x16x32_bf16 v[34:37], v[94:97], a[180:183], v[34:37]
  v_mul_f32 v54, v54, v158
  v_mul_f32 v55, v55, v159
  s_waitcnt lgkmcnt(4)
  v_mfma_f32_16x16x32_bf16 v[18:21], v[98:101], a[176:179], v[18:21]
  v_mul_f32 v56, v56, v160
  v_mul_f32 v57, v57, v161
  v_add_f32 v58, v58, v78
  v_mfma_f32_16x16x32_bf16 v[38:41], v[98:101], a[180:183], v[38:41]
  v_add_f32 v59, v59, v79
  v_add_f32 v60, v60, v80
  v_add_f32 v61, v61, v81
  s_waitcnt vmcnt(0) lgkmcnt(3)
  v_mfma_f32_16x16x32_bf16 v[22:25], v[102:105], a[188:191], v[22:25]
  v_mul_f32 v162, s32, v58
  v_mul_f32 v163, s32, v59
  v_mul_f32 v164, s32, v60
  s_waitcnt lgkmcnt(2)
  v_mfma_f32_16x16x32_bf16 v[26:29], v[106:109], a[188:191], v[26:29]
  v_mul_f32 v165, s32, v61
  s_waitcnt lgkmcnt(1)
  v_mfma_f32_16x16x32_bf16 v[30:33], v[110:113], a[188:191], v[30:33]
  v_exp_f32 v162, v162
  s_waitcnt lgkmcnt(0)
  v_mfma_f32_16x16x32_bf16 v[34:37], v[114:117], a[188:191], v[34:37]
  v_exp_f32 v163, v163
  v_mfma_f32_16x16x32_bf16 v[38:41], v[118:121], a[188:191], v[38:41]
  v_exp_f32 v164, v164
  v_mfma_f32_16x16x32_bf16 v[2:5], v[102:105], a[184:187], v[2:5]
  v_exp_f32 v165, v165
  v_mfma_f32_16x16x32_bf16 v[6:9], v[106:109], a[184:187], v[6:9]
  v_add_f32 v162, 1.0, v162
  v_add_f32 v163, 1.0, v163
  v_add_f32 v164, 1.0, v164
  v_mfma_f32_16x16x32_bf16 v[10:13], v[110:113], a[184:187], v[10:13]
  ds_write_b128 v139, v[22:25] offset:20480
  v_add_f32 v165, 1.0, v165
  v_mfma_f32_16x16x32_bf16 v[14:17], v[114:117], a[184:187], v[14:17]
  ds_write_b128 v139, v[26:29] offset:21504
  v_rcp_f32 v162, v162
  v_mfma_f32_16x16x32_bf16 v[18:21], v[118:121], a[184:187], v[18:21]
  ds_write_b128 v139, v[30:33] offset:22528
  ds_write_b128 v139, v[34:37] offset:23552
  ds_write_b128 v139, v[38:41] offset:24576
  v_rcp_f32 v163, v163
  v_rcp_f32 v164, v164
  v_rcp_f32 v165, v165
  v_mul_f32 v58, v58, v162
  v_mul_f32 v59, v59, v163
  v_mul_f32 v60, v60, v164
  v_mul_f32 v61, v61, v165
  s_waitcnt lgkmcnt(0)
  s_barrier
  ds_read_b128 v[22:25], v140 offset:20480
  ds_read_b128 v[26:29], v140 offset:21504
  ds_read_b128 v[30:33], v140 offset:22528
  ds_read_b128 v[34:37], v140 offset:23552
  ds_read_b128 v[38:41], v140 offset:24576
  v_pk_fma_f32 v[146:147], v[2:3], v[42:43], v[166:167]
  v_pk_fma_f32 v[148:149], v[4:5], v[44:45], v[168:169]
  v_pk_fma_f32 v[150:151], v[6:7], v[46:47], v[170:171]
  v_pk_fma_f32 v[152:153], v[8:9], v[48:49], v[172:173]
  v_pk_fma_f32 v[154:155], v[10:11], v[50:51], v[174:175]
  v_pk_fma_f32 v[156:157], v[12:13], v[52:53], v[176:177]
  v_pk_fma_f32 v[158:159], v[14:15], v[54:55], v[178:179]
  v_pk_fma_f32 v[160:161], v[16:17], v[56:57], v[180:181]
  v_pk_fma_f32 v[162:163], v[18:19], v[58:59], v[182:183]
  v_pk_fma_f32 v[164:165], v[20:21], v[60:61], v[184:185]
  s_waitcnt lgkmcnt(0)
  v_pk_fma_f32 v[2:3], v[22:23], v[42:43], v[146:147]
  v_pk_fma_f32 v[4:5], v[24:25], v[44:45], v[148:149]
  v_pk_fma_f32 v[6:7], v[26:27], v[46:47], v[150:151]
  v_pk_fma_f32 v[8:9], v[28:29], v[48:49], v[152:153]
  v_pk_fma_f32 v[10:11], v[30:31], v[50:51], v[154:155]
  v_pk_fma_f32 v[12:13], v[32:33], v[52:53], v[156:157]
  v_pk_fma_f32 v[14:15], v[34:35], v[54:55], v[158:159]
  v_pk_fma_f32 v[16:17], v[36:37], v[56:57], v[160:161]
  v_pk_fma_f32 v[18:19], v[38:39], v[58:59], v[162:163]
  v_pk_fma_f32 v[20:21], v[40:41], v[60:61], v[164:165]
  v_cvt_pk_bf16_f32 v122, v2, v3
  v_cvt_pk_bf16_f32 v123, v4, v5
  v_cvt_pk_bf16_f32 v124, v6, v7
  v_cvt_pk_bf16_f32 v125, v8, v9
  buffer_store_dwordx4 v[122:125], v137, s[28:31], 0 offen offset:0
  v_cvt_pk_bf16_f32 v126, v10, v11
  v_cvt_pk_bf16_f32 v127, v12, v13
  v_cvt_pk_bf16_f32 v128, v14, v15
  v_cvt_pk_bf16_f32 v129, v16, v17
  buffer_store_dwordx4 v[126:129], v137, s[28:31], 0 offen offset:16
  v_cvt_pk_bf16_f32 v130, v18, v19
  v_cvt_pk_bf16_f32 v131, v20, v21
  buffer_store_dwordx2 v[130:131], v137, s[28:31], 0 offen offset:32
  s_waitcnt vmcnt(0)
  s_endpgm
k2_sw:
  s_mov_b64 s[20:21], s[40:41]
  s_mov_b64 s[24:25], s[40:41]
  s_mov_b32 s22, s42
  s_mov_b32 s26, s42
  s_movk_i32 s58, 16384
  s_movk_i32 s53, 12288
  s_movk_i32 s50, -16384
  s_movk_i32 s51, -12288
  v_add_u32 v189, s54, v196
  v_add_u32 v190, s54, v196
  v_add_u32 v191, s54, v196
  v_add_u32 v192, s54, v196
  v_add_u32 v193, s55, v196
  v_add_u32 v194, s55, v196
  v_add_u32 v195, s55, v196
  v_lshlrev_b32 v254, 6, v0
  v_min_u32 v254, k2_sw-k2_lx, v254
  v_add_u32 v254, k2_lx-k2_pc, v254
  global_load_dword v255, v254, s[96:97]
  s_branch k2_swr
k2_fall:
  s_waitcnt vmcnt(0)
  s_mov_b32 s57, -1
  s_mov_b32 s60, 0
  s_lshl_b32 s47, s11, 18
  s_add_u32 s20, s14, s47
  s_addc_u32 s21, s15, 0
  s_cmp_lt_u32 s12, 7
  s_cselect_b32 s22, 262144, 0
  s_mov_b64 s[24:25], s[4:5]
  s_mov_b32 s26, 8388608
  s_mov_b32 s53, 5120
  s_cmp_lt_u32 s10, 2
  s_cselect_b32 s53, 327680, s53
  s_mov_b32 s30, s59
  s_lshl_b32 s47, s12, 2
  s_add_u32 s47, s47, s10
  s_mul_i32 s47, s47, 163840
  v_subrev_u32 v68, s47, v197
  v_subrev_u32 v69, s47, v198
  v_mov_b32 v66, 0xff800000
  v_mov_b32 v67, 0xff800000
  s_mov_b32 s47, 40960
k2_fl:
  buffer_load_dwordx4 v[110:113], v68, s[24:27], s47 offen sc1
  buffer_load_dwordx2 v[118:119], v69, s[24:27], s47 offen sc1
  s_waitcnt vmcnt(0)
  v_mfma_f32_32x32x16_bf16 v[2:17], v[110:113], v[98:101], 0
  v_mfma_f32_32x32x16_bf16 v[18:33], v[110:113], v[102:105], 0
  v_mfma_f32_32x32x8_bf16 v[2:17], v[118:119], v[106:107], v[2:17]
  v_mfma_f32_32x32x8_bf16 v[18:33], v[118:119], v[108:109], v[18:33]
  s_nop 7
  s_nop 7
  v_max3_f32 v66, v2, v3, v66
  v_max3_f32 v66, v4, v5, v66
  v_max3_f32 v66, v6, v7, v66
  v_max3_f32 v66, v8, v9, v66
  v_max3_f32 v66, v10, v11, v66
  v_max3_f32 v66, v12, v13, v66
  v_max3_f32 v66, v14, v15, v66
  v_max3_f32 v66, v16, v17, v66
  v_max3_f32 v67, v18, v19, v67
  v_max3_f32 v67, v20, v21, v67
  v_max3_f32 v67, v22, v23, v67
  v_max3_f32 v67, v24, v25, v67
  v_max3_f32 v67, v26, v27, v67
  v_max3_f32 v67, v28, v29, v67
  v_max3_f32 v67, v30, v31, v67
  v_max3_f32 v67, v32, v33, v67
  s_add_u32 s47, s47, 81920
  s_cmp_lt_u32 s47, 5242880
  s_cbranch_scc1 k2_fl
  v_cmp_gt_u32 vcc, 32, v203
  s_mov_b32 s49, 0xffff0000
  v_mov_b32 v208, v66
  s_nop 1
  v_permlane32_swap_b32 v208, v66
  s_nop 1
  v_max_f32 v208, v208, v66
  v_sub_f32 v208, 0, v208
  v_and_b32 v209, s49, v208
  v_sub_f32 v208, v208, v209
  v_and_b32 v210, s49, v208
  v_sub_f32 v208, v208, v210
  v_lshrrev_b32 v209, 16, v209
  v_or_b32 v209, v209, v210
  v_lshrrev_b32 v208, 16, v208
  v_cndmask_b32 v106, v209, v106, vcc
  v_cndmask_b32 v107, v208, v107, vcc
  v_mov_b32 v208, v67
  s_nop 1
  v_permlane32_swap_b32 v208, v67
  s_nop 1
  v_max_f32 v208, v208, v67
  v_sub_f32 v208, 0, v208
  v_and_b32 v209, s49, v208
  v_sub_f32 v208, v208, v209
  v_and_b32 v210, s49, v208
  v_sub_f32 v208, v208, v210
  v_lshrrev_b32 v209, 16, v209
  v_or_b32 v209, v209, v210
  v_lshrrev_b32 v208, 16, v208
  v_cndmask_b32 v108, v209, v108, vcc
  v_cndmask_b32 v109, v208, v109, vcc
  s_barrier
  s_branch k2_restart
k2_end:
  s_endpgm
.section .rodata,"a"
.p2align 6
.amdhsa_kernel k1_kernel
  .amdhsa_next_free_vgpr 512
  .amdhsa_next_free_sgpr 102
  .amdhsa_accum_offset 256
  .amdhsa_group_segment_fixed_size 0
  .amdhsa_kernarg_size 88
  .amdhsa_user_sgpr_count 2
  .amdhsa_user_sgpr_kernarg_segment_ptr 1
  .amdhsa_system_sgpr_workgroup_id_x 1
.end_amdhsa_kernel
```
